```python
import torch

def _softmax(x, axis=-1):
    return torch.softmax(x, dim=axis)
def _gelu(x):
    return torch.nn.functional.gelu(x, approximate="tanh")
def _silu(x):
    return torch.nn.functional.silu(x)
def _sigmoid(x):
    return torch.sigmoid(x)
def _layernorm(x, axis=-1, eps=1e-5):
    m = x.mean(dim=axis, keepdim=True)
    v = x.var(dim=axis, keepdim=True, unbiased=False)
    return (x - m) / torch.sqrt(v + eps)
def _scatter_add(tgt, idx, src, axis=0):
    return tgt.clone().index_add_(axis, idx, src)
def _segment_sum(src, seg, n):
    out = torch.zeros((n,) + src.shape[1:], dtype=src.dtype)
    return out.index_add_(0, seg, src)
def _pad(x, pw):
    flat = tuple(v for pair in reversed(pw) for v in pair)
    return torch.nn.functional.pad(x, flat)

kernel_name = 'parallel_sum__ssm_conv_s4d__dense_activation_squared_relu__prompt'

def setup_inputs():

    _w = (lambda a: (lambda t: t.to(torch.bfloat16) if t.is_floating_point() else t)(torch.as_tensor(a)))
    def _A_setup():
        Bsz, L, D, N = 1, 2048, 512, 128
        return {
            "u": _w((lambda *s: torch.randn(*s, dtype=torch.bfloat16) * 0.05)(Bsz, L, D)),
            "log_A_real": _w((lambda *s: torch.randn(*s, dtype=torch.bfloat16) * 3.2)(D, N) * 0.5),
            "A_imag": _w((lambda *s: torch.randn(*s, dtype=torch.bfloat16) * 0.2)(D, N) * 3.14),
            "C_real": _w((lambda *s: torch.randn(*s, dtype=torch.bfloat16) * 3.2)(D, N) / N ** 0.5),
            "C_imag": _w((lambda *s: torch.randn(*s, dtype=torch.bfloat16) * 3.2)(D, N) / N ** 0.5),
            "log_dt": _w((lambda *s: torch.randn(*s, dtype=torch.bfloat16) * 0.2)(D) * 0.5 - 4.0),
            "D_skip": _w((lambda *s: torch.randn(*s, dtype=torch.bfloat16) * 0.4)(D)),
        }
    _A_in = _A_setup()

    def _B_setup():
        B, S, D, F = 1, 2048, 512, 1376
        return {
            "x": _w((lambda *s: torch.randn(*s, dtype=torch.bfloat16) * 0.05)(B, S, D)),
            "w1": _w((lambda *s: torch.randn(*s, dtype=torch.bfloat16) * 0.05)(D, F)),
            "b1": _w((lambda *s: torch.randn(*s, dtype=torch.bfloat16) * 0.2)(F)),
            "w2": _w((lambda *s: torch.randn(*s, dtype=torch.bfloat16) * 0.05)(F, D)),
            "b2": _w((lambda *s: torch.randn(*s, dtype=torch.bfloat16) * 0.8)(D)),
        }
    _B_in = _B_setup()

    return {
        "A_u": _A_in["u"],
        "A_log_A_real": _A_in["log_A_real"],
        "A_A_imag": _A_in["A_imag"],
        "A_C_real": _A_in["C_real"],
        "A_C_imag": _A_in["C_imag"],
        "A_log_dt": _A_in["log_dt"],
        "A_D_skip": _A_in["D_skip"],
        "B_x": _B_in["x"],
        "B_w1": _B_in["w1"],
        "B_b1": _B_in["b1"],
        "B_w2": _B_in["w2"],
        "B_b2": _B_in["b2"],
    }

def reference(A_u, A_log_A_real, A_A_imag, A_C_real, A_C_imag, A_log_dt, A_D_skip, B_x, B_w1, B_b1, B_w2, B_b2):
    def _A_ref(u, log_A_real, A_imag, C_real, C_imag, log_dt, D_skip):
        L = u.shape[1]
        dt = torch.exp(log_dt)
        A = -torch.exp(log_A_real) + 1j * A_imag
        C = (C_real + 1j * C_imag) * dt[:, None]
        pos = (lambda x, dt: x.to(dt))(torch.arange(L), log_dt.dtype)
        P = torch.exp((A * dt[:, None])[:, :, None] * pos[None, None, :])
        K = 2.0 * torch.einsum("dn,dnl->dl", C, P).real
        L2 = 2 * L
        u_t = (lambda x, *d: x.permute(*d))(u, 0, 2, 1)
        Kf = (lambda x, *a, **k: torch.fft.rfft(x.float(), *a, **k))(K, L2)
        Uf = (lambda x, *a, **k: torch.fft.rfft(x.float(), *a, **k))(u_t, L2)
        y = (lambda x, *a, **k: torch.fft.irfft(x, *a, **k).to(torch.bfloat16))(Uf * Kf[None, :, :], L2)[:, :, :L]
        y = (lambda x, *d: x.permute(*d))(y, 0, 2, 1)
        return y + u * D_skip[None, None, :]

    def _B_ref(x, w1, b1, w2, b2):
        h = torch.einsum("bsd,df->bsf", x, w1) + b1
        zero = torch.zeros_like(h)
        r = torch.where(h > zero, h, zero)
        h = r * r
        out = torch.einsum("bsf,fd->bsd", h, w2) + b2
        return out

    x = A_u
    xn = _layernorm(x, axis=-1)
    return x + _A_ref(xn, A_log_A_real, A_A_imag, A_C_real, A_C_imag, A_log_dt, A_D_skip) + _B_ref(xn, B_w1, B_b1, B_w2, B_b2)
```

```asm
; @launch grid=(256,1,1) block=(512,1,1) lds=163840
.amdgcn_target "amdgcn-amd-amdhsa--gfx950"
.text
.globl parallel_sum__ssm_conv_s4d__dense_activation_squared_relu__prompt_kernel
.p2align 8
.type parallel_sum__ssm_conv_s4d__dense_activation_squared_relu__prompt_kernel,@function
parallel_sum__ssm_conv_s4d__dense_activation_squared_relu__prompt_kernel:
    s_cmp_ge_u32 s2, 256
    s_cbranch_scc1 Lexit
    v_lshrrev_b32 v2, 6, v0
    v_and_b32 v1, 63, v0
    v_readfirstlane_b32 s3, v2
    s_mov_b32 s4, s2
    s_and_b32 s5, s3, 3
    s_cmp_lt_u32 s3, 4
    s_cbranch_scc1 Lrole_d
    s_setprio 2
    s_load_dwordx2 s[8:9], s[0:1], 0
    s_load_dwordx2 s[20:21], s[0:1], 112
    s_load_dwordx2 s[28:29], s[0:1], 72
    s_load_dwordx2 s[32:33], s[0:1], 88
    s_load_dwordx2 s[16:17], s[0:1], 80
    s_load_dwordx2 s[24:25], s[0:1], 96
    s_and_b32 s3, s4, 7
    s_lshr_b32 s7, s4, 3
    s_lshl_b32 s43, s3, 5
    s_add_u32 s7, s7, s43
    s_bfe_u32 s34, s4, 0x10003
    s_lshl_b32 s43, s3, 1
    s_add_u32 s34, s34, s43
    s_lshr_b32 s35, s4, 4
    s_bfe_u32 s48, s4, 0x10004
    s_lshl_b32 s43, s34, 1
    s_add_u32 s48, s48, s43
    s_lshr_b32 s49, s4, 5
    s_add_u32 s49, s49, s3
    s_and_b32 s49, s49, 7
    s_lshl_b32 s52, s5, 12
    s_mov_b32 s10, 2097152
    s_mov_b32 s11, 0x20000
    s_mov_b32 s22, 15728640
    s_mov_b32 s23, 0x20000
    s_mov_b32 s18, 1409024
    s_mov_b32 s19, 0x20000
    s_mov_b32 s26, 2097152
    s_mov_b32 s27, 0x20000
    s_mov_b32 s30, 2752
    s_mov_b32 s31, 0x20000
    s_lshl_b32 s3, s7, 13
    s_lshl_b32 s43, s5, 11
    s_add_u32 s3, s3, s43
    v_lshl_add_u32 v136, v1, 4, s3
    v_mov_b32 v115, 14680064
    v_mov_b32 v250, 152832
    v_mov_b32 v2, 0
    v_lshl_add_u32 v3, v1, 2, v250
    ds_write_b32 v3, v2
    s_waitcnt lgkmcnt(0)
    buffer_load_dwordx4 v[140:143], v136, s[8:11], 0 offen
    buffer_load_dwordx4 v[144:147], v136, s[8:11], 0 offen offset:1024
    buffer_load_dword v115, v115, s[20:23], 0 offen sc1
    s_barrier
    s_branch Lrole_m
Lrole_d:
    s_cmp_lg_u32 s5, 0
    s_cbranch_scc1 Lnocpf
    s_getpc_b64 s[8:9]
Lpc:
    s_sub_u32 s8, s8, Lpc-parallel_sum__ssm_conv_s4d__dense_activation_squared_relu__prompt_kernel
    s_subb_u32 s9, s9, 0
    s_lshr_b32 s10, s2, 3
    s_mul_i32 s10, s10, 6
    v_add_u32 v3, s10, v1
    v_min_u32 v3, (Lexit-parallel_sum__ssm_conv_s4d__dense_activation_squared_relu__prompt_kernel)/128, v3
    v_lshlrev_b32 v3, 7, v3
    v_mov_b32 v5, s9
    v_add_co_u32 v4, vcc, s8, v3
    s_nop 1
    v_addc_co_u32 v5, vcc, 0, v5, vcc
    s_mov_b64 exec, 0x3f
    global_load_dword v2, v[4:5], off
    s_mov_b64 exec, -1
Lnocpf:
    s_load_dwordx16 s[8:23], s[0:1], 0
    s_load_dwordx2 s[56:57], s[0:1], 64
    s_load_dwordx2 s[44:45], s[0:1], 112
    s_load_dwordx2 s[60:61], s[0:1], 80
    s_and_b32 s3, s4, 7
    s_lshr_b32 s7, s4, 3
    s_lshl_b32 s43, s3, 5
    s_add_u32 s7, s7, s43
    s_bfe_u32 s34, s4, 0x10003
    s_lshl_b32 s43, s3, 1
    s_add_u32 s34, s34, s43
    s_lshr_b32 s35, s4, 4
    s_bfe_u32 s48, s4, 0x10004
    s_lshl_b32 s43, s34, 1
    s_add_u32 s48, s48, s43
    s_lshr_b32 s49, s4, 5
    s_add_u32 s49, s49, s3
    s_and_b32 s49, s49, 7
    s_lshl_b32 s52, s5, 12
    s_mov_b32 s26, 2097152
    s_mov_b32 s27, 0x20000
    s_mov_b32 s58, 1409024
    s_mov_b32 s59, 0x20000
    s_mov_b32 s62, 1409024
    s_mov_b32 s63, 0x20000
    s_mov_b32 s46, 15728640
    s_mov_b32 s47, 0x20000
    s_and_b32 s31, s5, 1
    s_lshl_b32 s30, s7, 1
    s_add_u32 s3, s31, s30
    s_lshl_b32 s3, s3, 8
    v_lshl_add_u32 v16, v1, 2, s3
    s_lshl_b32 s30, s7, 2
    s_mov_b32 s3, s49
    s_and_b32 s3, s3, 7
    s_mul_i32 s3, s3, 0x11111111
    s_add_u32 s54, s3, 0x76543210
    s_mul_i32 s3, s5, 44032
    s_mul_i32 s43, s35, 192
    s_add_u32 s3, s3, s43
    s_movk_i32 s43, 2560
    s_mul_i32 s42, s35, 12
    s_sub_i32 s42, 172, s42
    v_mov_b32 v29, 0x7ff00000
    v_lshl_add_u32 v31, v1, 4, s3
    v_add_u32 v3, 0, v1
    v_mul_u32_u24 v3, 0x5556, v3
    v_lshrrev_b32 v3, 18, v3
    v_mad_u32_u24 v232, v3, s43, v31
    v_mul_u32_u24 v3, 12, v3
    v_sub_u32 v3, v1, v3
    v_add_u32 v3, 0, v3
    v_cmp_le_i32 vcc, s42, v3
    s_nop 1
    v_cndmask_b32 v232, v232, v29, vcc
    v_add_u32 v3, 64, v1
    v_mul_u32_u24 v3, 0x5556, v3
    v_lshrrev_b32 v3, 18, v3
    v_mad_u32_u24 v233, v3, s43, v31
    v_mul_u32_u24 v3, 12, v3
    v_sub_u32 v3, v1, v3
    v_add_u32 v3, 64, v3
    v_cmp_le_i32 vcc, s42, v3
    s_nop 1
    v_cndmask_b32 v233, v233, v29, vcc
    v_add_u32 v3, 128, v1
    v_mul_u32_u24 v3, 0x5556, v3
    v_lshrrev_b32 v3, 18, v3
    v_mad_u32_u24 v234, v3, s43, v31
    v_mul_u32_u24 v3, 12, v3
    v_sub_u32 v3, v1, v3
    v_add_u32 v3, 128, v3
    v_cmp_le_i32 vcc, s42, v3
    s_nop 1
    v_cndmask_b32 v234, v234, v29, vcc
    v_lshrrev_b32 v3, 3, v1
    v_lshrrev_b32 v30, 4, v1
    v_and_b32 v31, 7, v1
    v_xor_b32 v31, v31, v30
    v_lshlrev_b32 v31, 4, v31
    v_lshl_add_u32 v31, v3, 10, v31
    s_lshl_b32 s3, s34, 17
    s_lshl_b32 s43, s5, 15
    s_add_u32 s3, s3, s43
    v_add_u32 v228, s3, v31
    v_xor_b32 v229, 64, v228
    v_add_u32 v229, 7168, v229
    v_add_u32 v230, 14336, v228
    v_add_u32 v231, 14336, v229
    s_lshl_b32 s40, s5, 12
    s_add_u32 s40, s40, 12288
    s_mul_i32 s41, s5, 3072
    s_waitcnt lgkmcnt(0)
    global_load_dword v4, v16, s[10:11]
    global_load_dword v5, v16, s[12:13]
    global_load_dword v6, v16, s[14:15]
    global_load_dword v7, v16, s[16:17]
    s_load_dword s28, s[18:19], s30
    s_load_dword s29, s[20:21], s30
    s_mov_b32 s24, s8
    s_mov_b32 s25, s9
    s_mov_b32 s22, s31
    s_lshr_b32 s23, s5, 1
    s_barrier
    s_add_u32 m0, s41, 28672
    s_bfe_u32 s3, s54, 0x30000
    s_mul_i32 s39, s3, 176128
    s_lshl_b32 s38, s3, 7
    buffer_load_dwordx4 v232, s[56:59], s39 offen offset:0 lds
    buffer_load_dwordx4 v233, s[56:59], s39 offen offset:1024 lds
    buffer_load_dwordx4 v234, s[56:59], s39 offen offset:2048 lds
    s_add_u32 m0, s40, 28672
    s_nop 0
    buffer_load_dwordx4 v228, s[24:27], s38 offen offset:0 lds
    buffer_load_dwordx4 v229, s[24:27], s38 offen offset:1024 lds
    buffer_load_dwordx4 v230, s[24:27], s38 offen offset:2048 lds
    buffer_load_dwordx4 v231, s[24:27], s38 offen offset:3072 lds
    s_cmp_eq_u32 s35, 15
    s_cselect_b32 s3, 0x7ff00000, 0
    v_or_b32 v228, s3, v228
    v_or_b32 v229, s3, v229
    v_or_b32 v230, s3, v230
    v_or_b32 v231, s3, v231
    v_mov_b32 v253, 152832
    v_and_b32 v20, 7, v1
    v_lshlrev_b32 v20, 2, v20
    v_bfe_u32 v21, v1, 3, 2
    s_cmp_lt_u32 s5, 2
    s_mov_b32 s51, 0x111
    s_cselect_b32 s32, 0x1234567, s51
    s_cselect_b32 s33, 0x122234, s51
    s_cselect_b32 s55, 0x11122, s51
    s_mov_b32 s51, 0x1a181614
    s_cselect_b32 s51, 0x110e0900, s51
    s_cselect_b32 s36, 0, 0xaaaaaaaa
    s_mov_b32 s37, 0
    v_cmp_eq_u32 vcc, 1, v21
    v_mov_b32 v22, s55
    v_mov_b32 v23, s33
    v_cndmask_b32 v22, v22, v23, vcc
    v_cmp_eq_u32 vcc, 0, v21
    v_mov_b32 v23, s32
    v_lshlrev_b32 v21, 3, v21
    v_cndmask_b32 v22, v22, v23, vcc
    v_bfe_u32 v22, v22, v20, 4
    v_bfe_u32 v23, s51, v21, 8
    v_add_u32 v22, v22, v23
    v_lshrrev_b32 v23, 5, v1
    s_mul_i32 s31, s22, 31680
    s_add_u32 s31, s31, 0
    v_lshl_add_u32 v24, v23, 4, s31
    s_movk_i32 s30, 528
    v_mad_u32_u24 v240, v22, s30, v24
    v_and_b32 v22, 31, v1
    v_mad_u32_u24 v241, v22, s30, v24
    s_mul_i32 s30, s23, 14784
    s_add_u32 s31, s31, s30
    v_lshl_add_u32 v244, v1, 3, s31
    s_mul_i32 s31, s22, 4576
    s_add_u32 s31, s31, 153088
    v_lshl_add_u32 v243, v1, 4, s31
    s_lshl_b32 s30, s23, 11
    s_sub_u32 s32, s31, s30
    s_add_u32 s32, s32, 2544
    v_lshlrev_b32 v22, 4, v22
    v_sub_u32 v22, s32, v22
    v_lshl_add_u32 v242, v23, 3, v22
    s_add_u32 m0, s41, 57344
    s_bfe_u32 s3, s54, 0x30004
    s_mul_i32 s39, s3, 176128
    s_lshl_b32 s38, s3, 7
    buffer_load_dwordx4 v232, s[56:59], s39 offen offset:0 lds
    buffer_load_dwordx4 v233, s[56:59], s39 offen offset:1024 lds
    buffer_load_dwordx4 v234, s[56:59], s39 offen offset:2048 lds
    v_and_b32 v20, 15, v1
    s_lshl_b32 s32, s23, 8
    s_add_u32 s31, s31, s32
    s_add_u32 s31, s31, 480
    v_lshlrev_b32 v22, 5, v20
    v_sub_u32 v22, s31, v22
    v_lshl_add_u32 v245, v30, 4, v22
    s_mul_i32 s31, s22, 16640
    s_add_u32 s31, s31, 86016
    s_add_u32 s33, s31, s32
    v_bfe_u32 v22, v1, 2, 2
    v_and_b32 v24, 3, v1
    v_mul_u32_u24 v25, 4160, v22
    v_lshl_add_u32 v25, v30, 4, v25
    v_lshl_add_u32 v25, v24, 3, v25
    v_add_u32 v246, s33, v25
    v_lshlrev_b32 v25, 2, v30
    v_xor_b32 v25, v25, v1
    s_lshl_b32 s3, s5, 13
    s_add_u32 s3, s3, 86016
    v_lshl_add_u32 v250, v25, 4, s3
    v_bfe_u32 v26, v1, 1, 2
    v_lshrrev_b32 v25, 3, v1
    v_lshlrev_b32 v27, 2, v26
    v_xor_b32 v25, v25, v27
    v_lshlrev_b32 v25, 4, v25
    v_lshl_add_u32 v25, v26, 8, v25
    v_and_b32 v24, 1, v1
    v_lshl_add_u32 v25, v24, 3, v25
    s_lshl_b32 s3, s5, 11
    s_add_u32 s3, s3, 86016
    v_add_u32 v251, s3, v25
    s_lshl_b32 s3, s5, 10
    s_add_u32 s3, s3, 86016
    v_lshl_add_u32 v252, v1, 2, s3
    v_lshrrev_b32 v25, 1, v1
    s_lshl_b32 s3, s5, 6
    v_add_u32 v25, s3, v25
    s_lshl_b32 s3, s7, 5
    s_sub_u32 s3, s3, 16384
    v_lshlrev_b32 v26, 13, v25
    v_lshl_add_u32 v26, v24, 4, v26
    v_add_u32 v247, s3, v26
    v_add_u32 v248, 8192, v247
    v_mul_u32_u24 v26, 16640, v24
    v_lshl_add_u32 v26, v25, 4, v26
    v_add_u32 v249, 86016, v26
    v_lshrrev_b32 v20, 3, v1
    v_and_b32 v21, 7, v1
    v_bfe_u32 v22, v1, 4, 1
    v_lshlrev_b32 v22, 2, v22
    v_xor_b32 v21, v21, v22
    v_lshlrev_b32 v21, 4, v21
    v_lshl_add_u32 v21, v20, 10, v21
    s_lshl_b32 s3, s49, 7
    v_add_u32 v236, s3, v21
    v_add_u32 v237, 7168, v236
    v_add_u32 v238, 14336, v236
    v_add_u32 v239, 21504, v236
    s_mul_i32 s50, s5, 360448
    s_waitcnt lgkmcnt(0)
    s_mov_b32 s8, s44
    s_mov_b32 s9, s45
    s_mov_b32 s10, 2097152
    s_mov_b32 s11, 0x20000
    s_lshl_b32 s30, s28, 16
    s_and_b32 s31, s28, 0xffff0000
    s_cmp_eq_u32 s22, 0
    s_cselect_b32 s28, s30, s31
    s_and_b32 s12, s29, 0xffff0000
    s_lshl_b32 s29, s29, 16
    v_mov_b32 v16, 0x3fb8aa3b
    v_mul_f32 v17, s28, v16
    v_exp_f32 v17, v17
    s_cmp_lt_u32 s5, 2
    s_cselect_b32 s32, 1.0, 0x41000000
    s_cselect_b32 s33, 0x43780000, s32
    s_cselect_b32 s55, 0xbe22f983, 0.15915494
    v_cvt_pk_bf16_f32 v17, v17, v17
    v_lshlrev_b32 v17, 16, v17
    s_waitcnt vmcnt(10)
    v_lshlrev_b32 v20, 16, v4
    v_and_b32 v21, 0xffff0000, v4
    v_mul_f32 v20, v20, v16
    v_mul_f32 v21, v21, v16
    v_exp_f32 v20, v20
    v_exp_f32 v21, v21
    v_lshlrev_b32 v22, 16, v5
    v_and_b32 v23, 0xffff0000, v5
    v_cvt_pk_bf16_f32 v18, v20, v21
    v_mul_f32 v22, v22, v17
    v_mul_f32 v23, v23, v17
    v_lshlrev_b32 v20, 16, v18
    v_and_b32 v21, 0xffff0000, v18
    v_mul_f32 v22, s55, v22
    v_mul_f32 v23, s55, v23
    v_mul_f32 v20, v20, v17
    v_mul_f32 v21, v21, v17
    v_mul_f32_e64 v20, -v20, v16
    v_mul_f32_e64 v21, -v21, v16
    v_mul_f32 v56, s32, v20
    v_mul_f32 v58, s32, v22
    v_mul_f32 v57, s32, v21
    v_mul_f32 v59, s32, v23
    v_mul_f32 v60, s33, v20
    v_mul_f32 v62, s33, v22
    v_mul_f32 v61, s33, v21
    v_mul_f32 v63, s33, v23
    v_exp_f32 v56, v56
    v_fract_f32 v58, v58
    v_exp_f32 v57, v57
    v_fract_f32 v59, v59
    v_exp_f32 v60, v60
    v_fract_f32 v62, v62
    v_exp_f32 v61, v61
    v_fract_f32 v63, v63
    v_cos_f32 v24, v58
    v_sin_f32 v25, v58
    v_cos_f32 v26, v59
    v_sin_f32 v27, v59
    v_cos_f32 v28, v62
    v_sin_f32 v29, v62
    v_cos_f32 v30, v63
    v_sin_f32 v31, v63
    v_mul_f32 v24, v24, v56
    v_mul_f32 v25, v25, v56
    v_mul_f32 v26, v26, v57
    v_mul_f32 v27, v27, v57
    v_mul_f32 v28, v28, v60
    v_mul_f32 v29, v29, v60
    v_mul_f32 v30, v30, v61
    v_mul_f32 v31, v31, v61
    s_cbranch_scc1 Lkg_h
    v_mov_b32 v32, v24
    v_mov_b32 v33, v25
    v_mov_b32 v34, v26
    v_mov_b32 v35, v27
    v_mov_b32 v36, v24
    v_mov_b32 v37, v25
    v_mov_b32 v38, v26
    v_mov_b32 v39, v27
    v_mov_b32 v40, v24
    v_mov_b32 v41, v25
    v_mov_b32 v42, v26
    v_mov_b32 v43, v27
    v_mov_b32 v48, 1.0
    v_mov_b32 v49, 0
    v_mov_b32 v50, 1.0
    v_mov_b32 v51, 0
    s_branch Lkg_go
Lkg_h:
    v_add_f32 v17, v17, v17
    v_lshlrev_b32 v48, 16, v6
    v_lshlrev_b32 v49, 16, v7
    v_and_b32 v50, 0xffff0000, v6
    v_and_b32 v51, 0xffff0000, v7
    v_mul_f32_e64 v32, -v25, v25
    v_mul_f32 v33, v24, v25
    v_mul_f32_e64 v34, -v27, v27
    v_mul_f32 v35, v26, v27
    v_fmac_f32 v32, v24, v24
    v_fmac_f32 v33, v25, v24
    v_fmac_f32 v34, v26, v26
    v_fmac_f32 v35, v27, v26
    v_mul_f32_e64 v36, -v33, v33
    v_mul_f32 v37, v32, v33
    v_mul_f32_e64 v38, -v35, v35
    v_mul_f32 v39, v34, v35
    v_fmac_f32 v36, v32, v32
    v_fmac_f32 v37, v33, v32
    v_fmac_f32 v38, v34, v34
    v_fmac_f32 v39, v35, v34
    v_mul_f32_e64 v40, -v37, v37
    v_mul_f32 v41, v36, v37
    v_mul_f32_e64 v42, -v39, v39
    v_mul_f32 v43, v38, v39
    v_fmac_f32 v40, v36, v36
    v_fmac_f32 v41, v37, v36
    v_fmac_f32 v42, v38, v38
    v_fmac_f32 v43, v39, v38
    v_mul_f32 v48, v48, v17
    v_mul_f32_e64 v49, -v49, v17
    v_mul_f32 v50, v50, v17
    v_mul_f32_e64 v51, -v51, v17
Lkg_go:
    v_mul_f32_e64 v52, -v49, v25
    v_mul_f32 v53, v48, v25
    v_mul_f32_e64 v54, -v51, v27
    v_mul_f32 v55, v50, v27
    v_cvt_pk_bf16_f32 v64, v48, v49
    v_cvt_pk_bf16_f32 v65, v50, v51
    s_add_u32 m0, s40, 57344
    s_nop 0
    buffer_load_dwordx4 v228, s[24:27], s38 offen offset:0 lds
    buffer_load_dwordx4 v229, s[24:27], s38 offen offset:1024 lds
    v_fmac_f32 v52, v48, v24
    v_fmac_f32 v53, v49, v24
    v_fmac_f32 v54, v50, v26
    v_fmac_f32 v55, v51, v26
    v_mul_f32_e64 v48, -v53, v25
    v_mul_f32 v49, v52, v25
    v_mul_f32_e64 v50, -v55, v27
    v_mul_f32 v51, v54, v27
    v_cvt_pk_bf16_f32 v66, v52, v53
    v_cvt_pk_bf16_f32 v67, v54, v55
    buffer_load_dwordx4 v230, s[24:27], s38 offen offset:2048 lds
    buffer_load_dwordx4 v231, s[24:27], s38 offen offset:3072 lds
    v_fmac_f32 v48, v52, v24
    v_fmac_f32 v49, v53, v24
    v_fmac_f32 v50, v54, v26
    v_fmac_f32 v51, v55, v26
    v_mul_f32_e64 v52, -v49, v25
    v_mul_f32 v53, v48, v25
    v_mul_f32_e64 v54, -v51, v27
    v_mul_f32 v55, v50, v27
    v_cvt_pk_bf16_f32 v68, v48, v49
    v_cvt_pk_bf16_f32 v69, v50, v51
    s_add_u32 m0, s41, 0
    s_bfe_u32 s3, s54, 0x30008
    s_mul_i32 s39, s3, 176128
    s_lshl_b32 s38, s3, 7
    buffer_load_dwordx4 v232, s[56:59], s39 offen offset:0 lds
    v_fmac_f32 v52, v48, v24
    v_fmac_f32 v53, v49, v24
    v_fmac_f32 v54, v50, v26
    v_fmac_f32 v55, v51, v26
    v_mul_f32_e64 v48, -v53, v25
    v_mul_f32 v49, v52, v25
    v_mul_f32_e64 v50, -v55, v27
    v_mul_f32 v51, v54, v27
    v_cvt_pk_bf16_f32 v70, v52, v53
    v_cvt_pk_bf16_f32 v71, v54, v55
    buffer_load_dwordx4 v233, s[56:59], s39 offen offset:1024 lds
    v_fmac_f32 v48, v52, v24
    v_fmac_f32 v49, v53, v24
    v_fmac_f32 v50, v54, v26
    v_fmac_f32 v51, v55, v26
    v_mul_f32_e64 v52, -v49, v25
    v_mul_f32 v53, v48, v25
    v_mul_f32_e64 v54, -v51, v27
    v_mul_f32 v55, v50, v27
    v_cvt_pk_bf16_f32 v72, v48, v49
    v_cvt_pk_bf16_f32 v73, v50, v51
    buffer_load_dwordx4 v234, s[56:59], s39 offen offset:2048 lds
    v_fmac_f32 v52, v48, v24
    v_fmac_f32 v53, v49, v24
    v_fmac_f32 v54, v50, v26
    v_fmac_f32 v55, v51, v26
    v_mul_f32_e64 v48, -v53, v25
    v_mul_f32 v49, v52, v25
    v_mul_f32_e64 v50, -v55, v27
    v_mul_f32 v51, v54, v27
    v_cvt_pk_bf16_f32 v74, v52, v53
    v_cvt_pk_bf16_f32 v75, v54, v55
    s_add_u32 m0, s40, 0
    s_nop 0
    buffer_load_dwordx4 v228, s[24:27], s38 offen offset:0 lds
    v_fmac_f32 v48, v52, v24
    v_fmac_f32 v49, v53, v24
    v_fmac_f32 v50, v54, v26
    v_fmac_f32 v51, v55, v26
    v_mul_f32_e64 v52, -v49, v25
    v_mul_f32 v53, v48, v25
    v_mul_f32_e64 v54, -v51, v27
    v_mul_f32 v55, v50, v27
    v_cvt_pk_bf16_f32 v76, v48, v49
    v_cvt_pk_bf16_f32 v77, v50, v51
    buffer_load_dwordx4 v229, s[24:27], s38 offen offset:1024 lds
    v_fmac_f32 v52, v48, v24
    v_fmac_f32 v53, v49, v24
    v_fmac_f32 v54, v50, v26
    v_fmac_f32 v55, v51, v26
    v_mul_f32_e64 v48, -v53, v25
    v_mul_f32 v49, v52, v25
    v_mul_f32_e64 v50, -v55, v27
    v_mul_f32 v51, v54, v27
    v_cvt_pk_bf16_f32 v78, v52, v53
    v_cvt_pk_bf16_f32 v79, v54, v55
    buffer_load_dwordx4 v230, s[24:27], s38 offen offset:2048 lds
    v_fmac_f32 v48, v52, v24
    v_fmac_f32 v49, v53, v24
    v_fmac_f32 v50, v54, v26
    v_fmac_f32 v51, v55, v26
    v_mul_f32_e64 v52, -v49, v29
    v_mul_f32 v53, v48, v29
    v_mul_f32_e64 v54, -v51, v31
    v_mul_f32 v55, v50, v31
    v_cvt_pk_bf16_f32 v80, v48, v49
    v_cvt_pk_bf16_f32 v81, v50, v51
    buffer_load_dwordx4 v231, s[24:27], s38 offen offset:3072 lds
    v_fmac_f32 v52, v48, v28
    v_fmac_f32 v53, v49, v28
    v_fmac_f32 v54, v50, v30
    v_fmac_f32 v55, v51, v30
    v_mul_f32_e64 v48, -v53, v33
    v_mul_f32 v49, v52, v33
    v_mul_f32_e64 v50, -v55, v35
    v_mul_f32 v51, v54, v35
    v_cvt_pk_bf16_f32 v82, v52, v53
    v_cvt_pk_bf16_f32 v83, v54, v55
    s_mul_i32 s3, s7, 5504
    s_mul_i32 s30, s5, 1408
    s_add_u32 s3, s3, s30
    v_lshlrev_b32 v19, 7, v1
    s_mov_b64 exec, 0x7ff
    buffer_load_dword v3, v19, s[60:63], s3 offen
    s_mov_b64 exec, -1
    v_fmac_f32 v48, v52, v32
    v_fmac_f32 v49, v53, v32
    v_fmac_f32 v50, v54, v34
    v_fmac_f32 v51, v55, v34
    s_waitcnt vmcnt(15)
    s_barrier
    v_mul_f32_e64 v52, -v49, v33
    v_mul_f32 v53, v48, v33
    v_mul_f32_e64 v54, -v51, v35
    v_mul_f32 v55, v50, v35
    v_cvt_pk_bf16_f32 v84, v48, v49
    v_cvt_pk_bf16_f32 v85, v50, v51
    v_fmac_f32 v52, v48, v32
    v_fmac_f32 v53, v49, v32
    v_fmac_f32 v54, v50, v34
    v_fmac_f32 v55, v51, v34
    v_mul_f32_e64 v48, -v53, v33
    v_mul_f32 v49, v52, v33
    v_mul_f32_e64 v50, -v55, v35
    v_mul_f32 v51, v54, v35
    v_cvt_pk_bf16_f32 v86, v52, v53
    v_cvt_pk_bf16_f32 v87, v54, v55
    v_fmac_f32 v48, v52, v32
    v_fmac_f32 v49, v53, v32
    v_fmac_f32 v50, v54, v34
    v_fmac_f32 v51, v55, v34
    v_mul_f32_e64 v52, -v49, v33
    v_mul_f32 v53, v48, v33
    v_mul_f32_e64 v54, -v51, v35
    v_mul_f32 v55, v50, v35
    v_cvt_pk_bf16_f32 v88, v48, v49
    v_cvt_pk_bf16_f32 v89, v50, v51
    v_fmac_f32 v52, v48, v32
    v_fmac_f32 v53, v49, v32
    v_fmac_f32 v54, v50, v34
    v_fmac_f32 v55, v51, v34
    s_waitcnt vmcnt(8)
    s_barrier
    v_mul_f32_e64 v48, -v53, v29
    v_mul_f32 v49, v52, v29
    v_mul_f32_e64 v50, -v55, v31
    v_mul_f32 v51, v54, v31
    v_cvt_pk_bf16_f32 v90, v52, v53
    v_cvt_pk_bf16_f32 v91, v54, v55
    s_add_u32 m0, s41, 28672
    s_bfe_u32 s3, s54, 0x3000c
    s_mul_i32 s39, s3, 176128
    s_lshl_b32 s38, s3, 7
    buffer_load_dwordx4 v232, s[56:59], s39 offen offset:0 lds
    buffer_load_dwordx4 v233, s[56:59], s39 offen offset:1024 lds
    buffer_load_dwordx4 v234, s[56:59], s39 offen offset:2048 lds
    s_add_u32 m0, s40, 28672
    s_nop 0
    buffer_load_dwordx4 v228, s[24:27], s38 offen offset:0 lds
    v_fmac_f32 v48, v52, v28
    v_fmac_f32 v49, v53, v28
    v_fmac_f32 v50, v54, v30
    v_fmac_f32 v51, v55, v30
    v_mul_f32_e64 v52, -v49, v37
    v_mul_f32 v53, v48, v37
    v_mul_f32_e64 v54, -v51, v39
    v_mul_f32 v55, v50, v39
    v_cvt_pk_bf16_f32 v92, v48, v49
    v_cvt_pk_bf16_f32 v93, v50, v51
    buffer_load_dwordx4 v229, s[24:27], s38 offen offset:1024 lds
    buffer_load_dwordx4 v230, s[24:27], s38 offen offset:2048 lds
    buffer_load_dwordx4 v231, s[24:27], s38 offen offset:3072 lds
    v_fmac_f32 v52, v48, v36
    v_fmac_f32 v53, v49, v36
    v_fmac_f32 v54, v50, v38
    v_fmac_f32 v55, v51, v38
    s_waitcnt vmcnt(8)
    s_barrier
    v_mul_f32_e64 v48, -v53, v37
    v_mul_f32 v49, v52, v37
    v_mul_f32_e64 v50, -v55, v39
    v_mul_f32 v51, v54, v39
    v_cvt_pk_bf16_f32 v94, v52, v53
    v_cvt_pk_bf16_f32 v95, v54, v55
    s_add_u32 m0, s41, 57344
    s_bfe_u32 s3, s54, 0x30010
    s_mul_i32 s39, s3, 176128
    s_lshl_b32 s38, s3, 7
    buffer_load_dwordx4 v232, s[56:59], s39 offen offset:0 lds
    buffer_load_dwordx4 v233, s[56:59], s39 offen offset:1024 lds
    buffer_load_dwordx4 v234, s[56:59], s39 offen offset:2048 lds
    v_fmac_f32 v48, v52, v36
    v_fmac_f32 v49, v53, v36
    v_fmac_f32 v50, v54, v38
    v_fmac_f32 v51, v55, v38
    v_mul_f32_e64 v52, -v49, v29
    v_mul_f32 v53, v48, v29
    v_mul_f32_e64 v54, -v51, v31
    v_mul_f32 v55, v50, v31
    v_cvt_pk_bf16_f32 v96, v48, v49
    v_cvt_pk_bf16_f32 v97, v50, v51
    s_add_u32 m0, s40, 57344
    s_nop 0
    buffer_load_dwordx4 v228, s[24:27], s38 offen offset:0 lds
    buffer_load_dwordx4 v229, s[24:27], s38 offen offset:1024 lds
    v_fmac_f32 v52, v48, v28
    v_fmac_f32 v53, v49, v28
    v_fmac_f32 v54, v50, v30
    v_fmac_f32 v55, v51, v30
    v_mul_f32_e64 v48, -v53, v37
    v_mul_f32 v49, v52, v37
    v_mul_f32_e64 v50, -v55, v39
    v_mul_f32 v51, v54, v39
    v_cvt_pk_bf16_f32 v98, v52, v53
    v_cvt_pk_bf16_f32 v99, v54, v55
    buffer_load_dwordx4 v230, s[24:27], s38 offen offset:2048 lds
    buffer_load_dwordx4 v231, s[24:27], s38 offen offset:3072 lds
    v_fmac_f32 v48, v52, v36
    v_fmac_f32 v49, v53, v36
    v_fmac_f32 v50, v54, v38
    v_fmac_f32 v51, v55, v38
    s_waitcnt vmcnt(7)
    s_barrier
    v_mul_f32_e64 v52, -v49, v37
    v_mul_f32 v53, v48, v37
    v_mul_f32_e64 v54, -v51, v39
    v_mul_f32 v55, v50, v39
    v_cvt_pk_bf16_f32 v100, v48, v49
    v_cvt_pk_bf16_f32 v101, v50, v51
    s_add_u32 m0, s41, 0
    s_bfe_u32 s3, s54, 0x30014
    s_mul_i32 s39, s3, 176128
    s_lshl_b32 s38, s3, 7
    buffer_load_dwordx4 v232, s[56:59], s39 offen offset:0 lds
    buffer_load_dwordx4 v233, s[56:59], s39 offen offset:1024 lds
    v_fmac_f32 v52, v48, v36
    v_fmac_f32 v53, v49, v36
    v_fmac_f32 v54, v50, v38
    v_fmac_f32 v55, v51, v38
    v_mul_f32_e64 v48, -v53, v29
    v_mul_f32 v49, v52, v29
    v_mul_f32_e64 v50, -v55, v31
    v_mul_f32 v51, v54, v31
    v_cvt_pk_bf16_f32 v102, v52, v53
    v_cvt_pk_bf16_f32 v103, v54, v55
    buffer_load_dwordx4 v234, s[56:59], s39 offen offset:2048 lds
    s_add_u32 m0, s40, 0
    s_nop 0
    buffer_load_dwordx4 v228, s[24:27], s38 offen offset:0 lds
    v_fmac_f32 v48, v52, v28
    v_fmac_f32 v49, v53, v28
    v_fmac_f32 v50, v54, v30
    v_fmac_f32 v51, v55, v30
    v_mul_f32_e64 v52, -v49, v41
    v_mul_f32 v53, v48, v41
    v_mul_f32_e64 v54, -v51, v43
    v_mul_f32 v55, v50, v43
    v_cvt_pk_bf16_f32 v104, v48, v49
    v_cvt_pk_bf16_f32 v105, v50, v51
    buffer_load_dwordx4 v229, s[24:27], s38 offen offset:1024 lds
    buffer_load_dwordx4 v230, s[24:27], s38 offen offset:2048 lds
    v_fmac_f32 v52, v48, v40
    v_fmac_f32 v53, v49, v40
    v_fmac_f32 v54, v50, v42
    v_fmac_f32 v55, v51, v42
    v_mul_f32_e64 v48, -v53, v29
    v_mul_f32 v49, v52, v29
    v_mul_f32_e64 v50, -v55, v31
    v_mul_f32 v51, v54, v31
    v_cvt_pk_bf16_f32 v106, v52, v53
    v_cvt_pk_bf16_f32 v107, v54, v55
    buffer_load_dwordx4 v231, s[24:27], s38 offen offset:3072 lds
    v_fmac_f32 v48, v52, v28
    v_fmac_f32 v49, v53, v28
    v_fmac_f32 v50, v54, v30
    v_fmac_f32 v51, v55, v30
    s_waitcnt vmcnt(7)
    s_barrier
    v_mul_f32_e64 v52, -v49, v41
    v_mul_f32 v53, v48, v41
    v_mul_f32_e64 v54, -v51, v43
    v_mul_f32 v55, v50, v43
    v_cvt_pk_bf16_f32 v108, v48, v49
    v_cvt_pk_bf16_f32 v109, v50, v51
    s_add_u32 m0, s41, 28672
    s_bfe_u32 s3, s54, 0x30018
    s_mul_i32 s39, s3, 176128
    s_lshl_b32 s38, s3, 7
    buffer_load_dwordx4 v232, s[56:59], s39 offen offset:0 lds
    buffer_load_dwordx4 v233, s[56:59], s39 offen offset:1024 lds
    v_fmac_f32 v52, v48, v40
    v_fmac_f32 v53, v49, v40
    v_fmac_f32 v54, v50, v42
    v_fmac_f32 v55, v51, v42
    v_mul_f32_e64 v48, -v53, v29
    v_mul_f32 v49, v52, v29
    v_mul_f32_e64 v50, -v55, v31
    v_mul_f32 v51, v54, v31
    v_cvt_pk_bf16_f32 v110, v52, v53
    v_cvt_pk_bf16_f32 v111, v54, v55
    buffer_load_dwordx4 v234, s[56:59], s39 offen offset:2048 lds
    s_add_u32 m0, s40, 28672
    s_nop 0
    buffer_load_dwordx4 v228, s[24:27], s38 offen offset:0 lds
    v_fmac_f32 v48, v52, v28
    v_fmac_f32 v49, v53, v28
    v_fmac_f32 v50, v54, v30
    v_fmac_f32 v51, v55, v30
    v_mul_f32_e64 v52, -v49, v41
    v_mul_f32 v53, v48, v41
    v_mul_f32_e64 v54, -v51, v43
    v_mul_f32 v55, v50, v43
    v_cvt_pk_bf16_f32 v112, v48, v49
    v_cvt_pk_bf16_f32 v113, v50, v51
    buffer_load_dwordx4 v229, s[24:27], s38 offen offset:1024 lds
    v_fmac_f32 v52, v48, v40
    v_fmac_f32 v53, v49, v40
    v_fmac_f32 v54, v50, v42
    v_fmac_f32 v55, v51, v42
    v_mul_f32_e64 v48, -v53, v29
    v_mul_f32 v49, v52, v29
    v_mul_f32_e64 v50, -v55, v31
    v_mul_f32 v51, v54, v31
    v_cvt_pk_bf16_f32 v114, v52, v53
    v_cvt_pk_bf16_f32 v115, v54, v55
    buffer_load_dwordx4 v230, s[24:27], s38 offen offset:2048 lds
    v_fmac_f32 v48, v52, v28
    v_fmac_f32 v49, v53, v28
    v_fmac_f32 v50, v54, v30
    v_fmac_f32 v51, v55, v30
    v_mul_f32_e64 v52, -v49, v41
    v_mul_f32 v53, v48, v41
    v_mul_f32_e64 v54, -v51, v43
    v_mul_f32 v55, v50, v43
    v_cvt_pk_bf16_f32 v116, v48, v49
    v_cvt_pk_bf16_f32 v117, v50, v51
    buffer_load_dwordx4 v231, s[24:27], s38 offen offset:3072 lds
    v_fmac_f32 v52, v48, v40
    v_fmac_f32 v53, v49, v40
    v_fmac_f32 v54, v50, v42
    v_fmac_f32 v55, v51, v42
    s_waitcnt vmcnt(7)
    s_barrier
    ds_read_b32 v60, v253 offset:40
    v_lshlrev_b32 v20, 4, v1
    s_mov_b32 s33, 14712832
    s_add_u32 m0, s41, 57344
    s_bfe_u32 s3, s54, 0x3001c
    s_mul_i32 s39, s3, 176128
    s_lshl_b32 s38, s3, 7
    buffer_load_dwordx4 v232, s[56:59], s39 offen offset:0 lds
    buffer_load_dwordx4 v233, s[56:59], s39 offen offset:1024 lds
    buffer_load_dwordx4 v234, s[56:59], s39 offen offset:2048 lds
    s_add_u32 m0, s40, 57344
    s_nop 0
    buffer_load_dwordx4 v228, s[24:27], s38 offen offset:0 lds
    buffer_load_dwordx4 v229, s[24:27], s38 offen offset:1024 lds
    buffer_load_dwordx4 v230, s[24:27], s38 offen offset:2048 lds
    buffer_load_dwordx4 v231, s[24:27], s38 offen offset:3072 lds
    v_mul_f32_e64 v48, -v53, v41
    v_mul_f32 v49, v52, v41
    v_mul_f32_e64 v50, -v55, v43
    v_mul_f32 v51, v54, v43
    v_cvt_pk_bf16_f32 v118, v52, v53
    v_cvt_pk_bf16_f32 v119, v54, v55
    v_fmac_f32 v48, v52, v40
    v_fmac_f32 v49, v53, v40
    v_fmac_f32 v50, v54, v42
    v_fmac_f32 v51, v55, v42
    v_mul_f32_e64 v52, -v49, v41
    v_mul_f32 v53, v48, v41
    v_mul_f32_e64 v54, -v51, v43
    v_mul_f32 v55, v50, v43
    v_cvt_pk_bf16_f32 v120, v48, v49
    v_cvt_pk_bf16_f32 v121, v50, v51
    v_fmac_f32 v52, v48, v40
    v_fmac_f32 v53, v49, v40
    v_fmac_f32 v54, v50, v42
    v_fmac_f32 v55, v51, v42
    v_mul_f32_e64 v48, -v53, v41
    v_mul_f32 v49, v52, v41
    v_mul_f32_e64 v50, -v55, v43
    v_mul_f32 v51, v54, v43
    v_cvt_pk_bf16_f32 v122, v52, v53
    v_cvt_pk_bf16_f32 v123, v54, v55
    v_fmac_f32 v48, v52, v40
    v_fmac_f32 v49, v53, v40
    v_fmac_f32 v50, v54, v42
    v_fmac_f32 v51, v55, v42
    v_mul_f32_e64 v52, -v49, v41
    v_mul_f32 v53, v48, v41
    v_mul_f32_e64 v54, -v51, v43
    v_mul_f32 v55, v50, v43
    v_cvt_pk_bf16_f32 v124, v48, v49
    v_cvt_pk_bf16_f32 v125, v50, v51
    v_fmac_f32 v52, v48, v40
    v_fmac_f32 v53, v49, v40
    v_fmac_f32 v54, v50, v42
    v_fmac_f32 v55, v51, v42
    v_cvt_pk_bf16_f32 v126, v52, v53
    v_cvt_pk_bf16_f32 v127, v54, v55
    v_mov_b32 v24, 0
    v_mov_b32 v25, 0
    v_mov_b32 v26, 0
    v_mov_b32 v27, 0
    s_waitcnt lgkmcnt(0)
    v_readfirstlane_b32 s6, v60
    s_waitcnt vmcnt(7)
    s_barrier
    buffer_load_dwordx4 v[128:131], v20, s[44:47], s33 offen sc1
    s_add_u32 m0, s52, 119296
    s_add_u32 s53, s50, 0
    buffer_load_dwordx4 v236, s[60:63], s53 offen offset:0 lds
    buffer_load_dwordx4 v237, s[60:63], s53 offen offset:1024 lds
    buffer_load_dwordx4 v238, s[60:63], s53 offen offset:2048 lds
    buffer_load_dwordx4 v239, s[60:63], s53 offen offset:3072 lds
    s_waitcnt vmcnt(5)
    s_barrier
    s_add_u32 m0, s52, 135680
    s_add_u32 s53, s50, 32768
    buffer_load_dwordx4 v236, s[60:63], s53 offen offset:0 lds
    buffer_load_dwordx4 v237, s[60:63], s53 offen offset:1024 lds
    buffer_load_dwordx4 v238, s[60:63], s53 offen offset:2048 lds
    buffer_load_dwordx4 v239, s[60:63], s53 offen offset:3072 lds
    s_waitcnt vmcnt(8)
    v_xor_b32 v132, s6, v128
    v_xor_b32 v133, s6, v129
    v_xor_b32 v134, s6, v130
    v_xor_b32 v135, s6, v131
    v_or3_b32 v132, v132, v133, v134
    v_or_b32 v132, v132, v135
    v_cmp_ne_u32 vcc, 0, v132
    s_mov_b32 s39, 1
    s_cbranch_vccnz Lc_skipu
    s_mov_b32 s39, 0
    s_mov_b32 s30, 262144
    v_add_u32 v22, s30, v247
    v_add_u32 v23, s30, v248
    s_cmp_lg_u32 s5, 3
    s_cbranch_scc1 Lc_no3a
    s_mov_b64 exec, 15
    buffer_load_dwordx4 v[144:147], v22, s[8:11], s30 offen sc1
    buffer_load_dwordx2 v[148:149], v23, s[8:11], s30 offen sc1
    s_mov_b64 exec, 1
    s_cmp_lg_u32 s4, 0
    s_cbranch_scc1 Lc_no3a
    v_mov_b32 v28, s6
    v_mov_b32 v29, 14680064
    buffer_store_dword v28, v29, s[44:47], 0 offen sc1
Lc_no3a:
    s_mov_b32 exec_lo, 0xc000c000
    s_mov_b32 exec_hi, 0xc000c000
    buffer_load_dwordx2 v[132:133], v248, s[8:11], 0 offen sc1
    buffer_load_dwordx2 v[140:141], v23, s[8:11], 0 offen sc1
    s_mov_b64 exec, -1
    buffer_load_dwordx4 v[128:131], v247, s[8:11], 0 offen sc1
    buffer_load_dwordx4 v[136:139], v22, s[8:11], 0 offen sc1
    s_waitcnt vmcnt(4)
    s_branch Lc_exb
Lc_skipu:
    s_waitcnt vmcnt(0)
    s_mov_b64 exec, vcc
    buffer_load_dwordx4 v[128:131], v20, s[44:47], s33 offen sc1
    s_mov_b64 exec, -1
Lc_exb:
    s_barrier
    s_setprio 0
    ds_write_b64 v244, v[64:65] offset:0
    ds_write_b64 v244, v[66:67] offset:528
    ds_write_b64 v244, v[68:69] offset:1056
    ds_write_b64 v244, v[70:71] offset:1584
    ds_write_b64 v244, v[72:73] offset:2112
    ds_write_b64 v244, v[74:75] offset:2640
    ds_write_b64 v244, v[76:77] offset:3168
    ds_write_b64 v244, v[78:79] offset:3696
    ds_write_b64 v244, v[80:81] offset:4224
    ds_write_b64 v244, v[82:83] offset:4752
    ds_write_b64 v244, v[84:85] offset:5280
    ds_write_b64 v244, v[86:87] offset:5808
    ds_write_b64 v244, v[88:89] offset:6336
    ds_write_b64 v244, v[90:91] offset:6864
    ds_write_b64 v244, v[92:93] offset:7392
    ds_write_b64 v244, v[94:95] offset:7920
    ds_write_b64 v244, v[96:97] offset:8448
    ds_write_b64 v244, v[98:99] offset:8976
    ds_write_b64 v244, v[100:101] offset:9504
    ds_write_b64 v244, v[102:103] offset:10032
    ds_write_b64 v244, v[104:105] offset:10560
    ds_write_b64 v244, v[106:107] offset:11088
    ds_write_b64 v244, v[108:109] offset:11616
    ds_write_b64 v244, v[110:111] offset:12144
    ds_write_b64 v244, v[112:113] offset:12672
    ds_write_b64 v244, v[114:115] offset:13200
    ds_write_b64 v244, v[116:117] offset:13728
    ds_write_b64 v244, v[118:119] offset:14256
    s_cmp_lt_u32 s5, 2
    s_cbranch_scc1 Lc_h28
    ds_write_b64 v244, v[120:121] offset:14784
    ds_write_b64 v244, v[122:123] offset:15312
    ds_write_b64 v244, v[124:125] offset:15840
    ds_write_b64 v244, v[126:127] offset:16368
Lc_h28:
    v_mov_b32 v21, 1
    s_mov_b64 exec, 1
    ds_add_u32 v253, v21 offset:24
    s_mov_b64 exec, -1
    s_cmp_eq_u32 s39, 0
    s_cbranch_scc1 Lc_build
    s_cmp_eq_u32 s39, 2
    s_cbranch_scc1 Lc_nobuild
    s_waitcnt vmcnt(0)
    v_xor_b32 v132, s6, v128
    v_xor_b32 v133, s6, v129
    v_xor_b32 v134, s6, v130
    v_xor_b32 v135, s6, v131
    v_or3_b32 v132, v132, v133, v134
    v_or_b32 v132, v132, v135
    v_cmp_ne_u32 vcc, 0, v132
    s_cbranch_vccnz Lc_nobuild
    s_mov_b32 s39, 2
    s_mov_b32 s30, 262144
    v_add_u32 v22, s30, v247
    v_add_u32 v23, s30, v248
    s_cmp_lg_u32 s5, 3
    s_cbranch_scc1 Lc_no3c
    s_mov_b64 exec, 15
    buffer_load_dwordx4 v[144:147], v22, s[8:11], s30 offen sc1
    buffer_load_dwordx2 v[148:149], v23, s[8:11], s30 offen sc1
    s_mov_b64 exec, 1
    s_cmp_lg_u32 s4, 0
    s_cbranch_scc1 Lc_no3c
    v_mov_b32 v28, s6
    v_mov_b32 v29, 14680064
    buffer_store_dword v28, v29, s[44:47], 0 offen sc1
Lc_no3c:
    s_mov_b32 exec_lo, 0xc000c000
    s_mov_b32 exec_hi, 0xc000c000
    buffer_load_dwordx2 v[132:133], v248, s[8:11], 0 offen sc1
    buffer_load_dwordx2 v[140:141], v23, s[8:11], 0 offen sc1
    s_mov_b64 exec, -1
    buffer_load_dwordx4 v[128:131], v247, s[8:11], 0 offen sc1
    buffer_load_dwordx4 v[136:139], v22, s[8:11], 0 offen sc1
    s_branch Lc_nobuild
Lc_build:
    s_waitcnt vmcnt(0)
    v_mov_b32_dpp v132, v128 row_shl:2 row_mask:0xf bank_mask:0xf
    v_mov_b32_dpp v133, v129 row_shl:2 row_mask:0xf bank_mask:0xf
    v_alignbyte_b32 v152, v129, v128, 2
    v_alignbyte_b32 v153, v130, v129, 2
    v_alignbyte_b32 v154, v131, v130, 2
    v_alignbyte_b32 v155, v132, v131, 2
    ds_write_b128 v249, v[130:133] offset:12480
    v_mov_b32 v156, v129
    v_mov_b32 v157, v130
    v_mov_b32 v158, v131
    v_mov_b32 v159, v132
    ds_write_b128 v249, v[152:155] offset:0
    v_alignbyte_b32 v160, v130, v129, 2
    v_alignbyte_b32 v161, v131, v130, 2
    v_alignbyte_b32 v162, v132, v131, 2
    v_alignbyte_b32 v163, v133, v132, 2
    ds_write_b128 v249, v[156:159] offset:4160
    ds_write_b128 v249, v[160:163] offset:8320
    v_mov_b32_dpp v140, v136 row_shl:2 row_mask:0xf bank_mask:0xf
    v_mov_b32_dpp v141, v137 row_shl:2 row_mask:0xf bank_mask:0xf
    v_alignbyte_b32 v164, v137, v136, 2
    v_alignbyte_b32 v165, v138, v137, 2
    v_alignbyte_b32 v166, v139, v138, 2
    v_alignbyte_b32 v167, v140, v139, 2
    ds_write_b128 v249, v[138:141] offset:12992
    v_mov_b32 v168, v137
    v_mov_b32 v169, v138
    v_mov_b32 v170, v139
    v_mov_b32 v171, v140
    ds_write_b128 v249, v[164:167] offset:512
    v_alignbyte_b32 v172, v138, v137, 2
    v_alignbyte_b32 v173, v139, v138, 2
    v_alignbyte_b32 v174, v140, v139, 2
    v_alignbyte_b32 v175, v141, v140, 2
    ds_write_b128 v249, v[168:171] offset:4672
    ds_write_b128 v249, v[172:175] offset:8832
    s_cmp_lg_u32 s5, 3
    s_cbranch_scc1 Lc_nob
    s_mov_b64 exec, 15
    v_alignbyte_b32 v176, v145, v144, 2
    v_alignbyte_b32 v177, v146, v145, 2
    v_alignbyte_b32 v178, v147, v146, 2
    v_alignbyte_b32 v179, v148, v147, 2
    ds_write_b128 v249, v[146:149] offset:13504
    v_mov_b32 v180, v145
    v_mov_b32 v181, v146
    v_mov_b32 v182, v147
    v_mov_b32 v183, v148
    ds_write_b128 v249, v[176:179] offset:1024
    v_alignbyte_b32 v184, v146, v145, 2
    v_alignbyte_b32 v185, v147, v146, 2
    v_alignbyte_b32 v186, v148, v147, 2
    v_alignbyte_b32 v187, v149, v148, 2
    ds_write_b128 v249, v[180:183] offset:5184
    ds_write_b128 v249, v[184:187] offset:9344
    s_mov_b64 exec, -1
Lc_nob:
    v_mov_b32 v21, 1
    s_mov_b64 exec, 1
    ds_add_u32 v253, v21 offset:32
    s_mov_b64 exec, -1
    s_cmp_lg_u32 s39, 0
    s_cbranch_scc1 Lc_built
Lc_nobuild:
    s_setprio 0
    s_mov_b32 s42, 1600000
Ll_tabw:
    ds_read_b32 v21, v253 offset:24
    s_waitcnt lgkmcnt(0)
    v_readfirstlane_b32 s3, v21
    s_sub_u32 s42, s42, 1
    s_cbranch_scc1 Ll_tabw_ok
    s_cmp_ge_u32 s3, 4
    s_cbranch_scc1 Ll_tabw_ok
    s_sleep 1
    s_branch Ll_tabw
Ll_tabw_ok:
    s_setprio 3
    ds_read_b128 v[64:67], v240 offset:0
    ds_read_b128 v[68:71], v241 offset:14784
    ds_read_b128 v[72:75], v240 offset:32
    ds_read_b128 v[76:79], v241 offset:14816
    ds_read_b128 v[80:83], v240 offset:64
    ds_read_b128 v[84:87], v241 offset:14848
    ds_read_b128 v[88:91], v240 offset:96
    ds_read_b128 v[92:95], v241 offset:14880
    ds_read_b128 v[96:99], v240 offset:128
    ds_read_b128 v[100:103], v241 offset:14912
    ds_read_b128 v[104:107], v240 offset:160
    ds_read_b128 v[108:111], v241 offset:14944
    ds_read_b128 v[112:115], v240 offset:192
    ds_read_b128 v[116:119], v241 offset:14976
    s_waitcnt lgkmcnt(12)
    v_mfma_f32_32x32x16_bf16 v[32:47], v[64:67], v[68:71], 0
    ds_read_b128 v[120:123], v240 offset:224
    ds_read_b128 v[124:127], v241 offset:15008
    s_waitcnt lgkmcnt(12)
    v_mfma_f32_32x32x16_bf16 v[32:47], v[72:75], v[76:79], v[32:47]
    ds_read_b128 v[64:67], v240 offset:256
    ds_read_b128 v[68:71], v241 offset:15040
    s_waitcnt lgkmcnt(12)
    v_mfma_f32_32x32x16_bf16 v[32:47], v[80:83], v[84:87], v[32:47]
    ds_read_b128 v[72:75], v240 offset:288
    ds_read_b128 v[76:79], v241 offset:15072
    s_waitcnt lgkmcnt(12)
    v_mfma_f32_32x32x16_bf16 v[32:47], v[88:91], v[92:95], v[32:47]
    ds_read_b128 v[80:83], v240 offset:320
    ds_read_b128 v[84:87], v241 offset:15104
    s_waitcnt lgkmcnt(12)
    v_mfma_f32_32x32x16_bf16 v[32:47], v[96:99], v[100:103], v[32:47]
    ds_read_b128 v[88:91], v240 offset:352
    ds_read_b128 v[92:95], v241 offset:15136
    s_waitcnt lgkmcnt(12)
    v_mfma_f32_32x32x16_bf16 v[32:47], v[104:107], v[108:111], v[32:47]
    ds_read_b128 v[96:99], v240 offset:384
    ds_read_b128 v[100:103], v241 offset:15168
    s_waitcnt lgkmcnt(12)
    v_mfma_f32_32x32x16_bf16 v[32:47], v[112:115], v[116:119], v[32:47]
    ds_read_b128 v[104:107], v240 offset:416
    ds_read_b128 v[108:111], v241 offset:15200
    s_waitcnt lgkmcnt(12)
    v_mfma_f32_32x32x16_bf16 v[32:47], v[120:123], v[124:127], v[32:47]
    ds_read_b128 v[112:115], v240 offset:448
    ds_read_b128 v[116:119], v241 offset:15232
    s_waitcnt lgkmcnt(12)
    v_mfma_f32_32x32x16_bf16 v[32:47], v[64:67], v[68:71], v[32:47]
    ds_read_b128 v[120:123], v240 offset:480
    ds_read_b128 v[124:127], v241 offset:15264
    s_waitcnt lgkmcnt(12)
    v_mfma_f32_32x32x16_bf16 v[32:47], v[72:75], v[76:79], v[32:47]
    s_waitcnt lgkmcnt(10)
    v_mfma_f32_32x32x16_bf16 v[32:47], v[80:83], v[84:87], v[32:47]
    s_mov_b64 exec, 0x3fffffff
    ds_write_b128 v243, v[24:27] offset:4096
    s_mov_b64 exec, -1
    s_waitcnt lgkmcnt(9)
    v_mfma_f32_32x32x16_bf16 v[32:47], v[88:91], v[92:95], v[32:47]
    s_waitcnt lgkmcnt(7)
    v_mfma_f32_32x32x16_bf16 v[32:47], v[96:99], v[100:103], v[32:47]
    s_waitcnt lgkmcnt(5)
    v_mfma_f32_32x32x16_bf16 v[32:47], v[104:107], v[108:111], v[32:47]
    s_waitcnt lgkmcnt(3)
    v_mfma_f32_32x32x16_bf16 v[32:47], v[112:115], v[116:119], v[32:47]
    s_waitcnt lgkmcnt(1)
    v_mfma_f32_32x32x16_bf16 v[32:47], v[120:123], v[124:127], v[32:47]
    s_nop 11
    v_cndmask_b32 v35, v35, v34, s[36:37]
    v_cndmask_b32 v39, v39, v38, s[36:37]
    v_cndmask_b32 v43, v43, v42, s[36:37]
    v_cndmask_b32 v47, v47, v46, s[36:37]
    v_cvt_pk_bf16_f32 v48, v32, v33
    v_cvt_pk_bf16_f32 v49, v34, v35
    ds_write_b64 v242, v[48:49] offset:1536
    v_cvt_pk_bf16_f32 v50, v36, v37
    v_cvt_pk_bf16_f32 v51, v38, v39
    ds_write_b64 v242, v[50:51] offset:1024
    v_cvt_pk_bf16_f32 v52, v40, v41
    v_cvt_pk_bf16_f32 v53, v42, v43
    ds_write_b64 v242, v[52:53] offset:512
    v_cvt_pk_bf16_f32 v54, v44, v45
    v_cvt_pk_bf16_f32 v55, v46, v47
    ds_write_b64 v242, v[54:55] offset:0
    v_mov_b32 v21, 1
    s_mov_b64 exec, 1
    ds_add_u32 v253, v21 offset:8
    s_mov_b64 exec, -1
    v_mov_b32 v21, 1
    s_mov_b64 exec, 1
    ds_add_u32 v253, v21 offset:32
    s_mov_b64 exec, -1
    s_setprio 0
    s_cmp_eq_u32 s39, 0
    s_cbranch_scc1 Lc_built
    s_cmp_eq_u32 s39, 2
    s_cbranch_scc1 Lc_build
    s_mov_b32 s31, 200000
Lc_poll:
    s_mov_b64 exec, vcc
    buffer_load_dwordx4 v[128:131], v20, s[44:47], s33 offen sc1
    s_mov_b64 exec, -1
    s_waitcnt vmcnt(0)
    v_xor_b32 v132, s6, v128
    v_xor_b32 v133, s6, v129
    v_xor_b32 v134, s6, v130
    v_xor_b32 v135, s6, v131
    v_or3_b32 v132, v132, v133, v134
    v_or_b32 v132, v132, v135
    v_cmp_ne_u32 vcc, 0, v132
    s_sub_u32 s31, s31, 1
    s_cbranch_scc1 Lc_poll_ok
    s_cbranch_vccz Lc_poll_ok
    s_sleep 8
    s_branch Lc_poll
Lc_poll_ok:
    s_mov_b32 s30, 262144
    v_add_u32 v22, s30, v247
    v_add_u32 v23, s30, v248
    s_cmp_lg_u32 s5, 3
    s_cbranch_scc1 Lc_no3b
    s_mov_b64 exec, 15
    buffer_load_dwordx4 v[144:147], v22, s[8:11], s30 offen sc1
    buffer_load_dwordx2 v[148:149], v23, s[8:11], s30 offen sc1
    s_mov_b64 exec, 1
    s_cmp_lg_u32 s4, 0
    s_cbranch_scc1 Lc_no3b
    v_mov_b32 v28, s6
    v_mov_b32 v29, 14680064
    buffer_store_dword v28, v29, s[44:47], 0 offen sc1
Lc_no3b:
    s_mov_b32 exec_lo, 0xc000c000
    s_mov_b32 exec_hi, 0xc000c000
    buffer_load_dwordx2 v[132:133], v248, s[8:11], 0 offen sc1
    buffer_load_dwordx2 v[140:141], v23, s[8:11], 0 offen sc1
    s_mov_b64 exec, -1
    buffer_load_dwordx4 v[128:131], v247, s[8:11], 0 offen sc1
    buffer_load_dwordx4 v[136:139], v22, s[8:11], 0 offen sc1
    s_branch Lc_build
Lc_built:
    s_waitcnt lgkmcnt(0)
    v_mov_b32 v32, 0
    v_mov_b32 v33, 0
    v_mov_b32 v34, 0
    v_mov_b32 v35, 0
    v_mov_b32 v36, 0
    v_mov_b32 v37, 0
    v_mov_b32 v38, 0
    v_mov_b32 v39, 0
    v_mov_b32 v40, 0
    v_mov_b32 v41, 0
    v_mov_b32 v42, 0
    v_mov_b32 v43, 0
    v_mov_b32 v44, 0
    v_mov_b32 v45, 0
    v_mov_b32 v46, 0
    v_mov_b32 v47, 0
    v_mov_b32 v48, 0
    v_mov_b32 v49, 0
    v_mov_b32 v50, 0
    v_mov_b32 v51, 0
    v_mov_b32 v52, 0
    v_mov_b32 v53, 0
    v_mov_b32 v54, 0
    v_mov_b32 v55, 0
    v_mov_b32 v56, 0
    v_mov_b32 v57, 0
    v_mov_b32 v58, 0
    v_mov_b32 v59, 0
    v_mov_b32 v60, 0
    v_mov_b32 v61, 0
    v_mov_b32 v62, 0
    v_mov_b32 v63, 0
    s_setprio 0
    s_mov_b32 s42, 1600000
Ll_built:
    ds_read_b32 v21, v253 offset:32
    s_waitcnt lgkmcnt(0)
    v_readfirstlane_b32 s3, v21
    s_sub_u32 s42, s42, 1
    s_cbranch_scc1 Ll_built_ok
    s_cmp_ge_u32 s3, 8
    s_cbranch_scc1 Ll_built_ok
    s_sleep 1
    s_branch Ll_built
Ll_built_ok:
    s_setprio 3
    ds_read_b128 v[64:67], v245 offset:3584
    ds_read_b64_tr_b16 v[96:97], v246 offset:0
    ds_read_b64_tr_b16 v[98:99], v246 offset:8
    ds_read_b128 v[68:71], v245 offset:3072
    ds_read_b64_tr_b16 v[100:101], v246 offset:512
    ds_read_b64_tr_b16 v[102:103], v246 offset:520
    ds_read_b128 v[72:75], v245 offset:2560
    ds_read_b64_tr_b16 v[104:105], v246 offset:1024
    ds_read_b64_tr_b16 v[106:107], v246 offset:1032
    ds_read_b128 v[76:79], v245 offset:2048
    ds_read_b64_tr_b16 v[108:109], v246 offset:1536
    ds_read_b64_tr_b16 v[110:111], v246 offset:1544
    s_waitcnt lgkmcnt(9)
    v_mfma_f32_16x16x32_bf16 v[32:35], v[96:99], v[64:67], v[32:35]
    ds_read_b128 v[80:83], v245 offset:1536
    ds_read_b64_tr_b16 v[112:113], v246 offset:2048
    ds_read_b64_tr_b16 v[114:115], v246 offset:2056
    s_waitcnt lgkmcnt(9)
    v_mfma_f32_16x16x32_bf16 v[36:39], v[96:99], v[68:71], v[36:39]
    ds_read_b128 v[84:87], v245 offset:1024
    ds_read_b64_tr_b16 v[116:117], v246 offset:2560
    ds_read_b64_tr_b16 v[118:119], v246 offset:2568
    v_mfma_f32_16x16x32_bf16 v[36:39], v[100:103], v[64:67], v[36:39]
    ds_read_b128 v[88:91], v245 offset:512
    ds_read_b64_tr_b16 v[120:121], v246 offset:3072
    s_waitcnt lgkmcnt(8)
    ds_read_b64_tr_b16 v[122:123], v246 offset:3080
    v_mfma_f32_16x16x32_bf16 v[40:43], v[100:103], v[68:71], v[40:43]
    ds_read_b128 v[92:95], v245 offset:0
    ds_read_b64_tr_b16 v[124:125], v246 offset:3584
    ds_read_b64_tr_b16 v[126:127], v246 offset:3592
    v_mfma_f32_16x16x32_bf16 v[40:43], v[96:99], v[72:75], v[40:43]
    ds_read_b128 v[128:131], v245 offset:3648
    v_mfma_f32_16x16x32_bf16 v[44:47], v[100:103], v[72:75], v[44:47]
    ds_read_b64_tr_b16 v[160:161], v246 offset:64
    v_mfma_f32_16x16x32_bf16 v[40:43], v[104:107], v[64:67], v[40:43]
    s_waitcnt lgkmcnt(8)
    ds_read_b64_tr_b16 v[162:163], v246 offset:72
    v_mfma_f32_16x16x32_bf16 v[44:47], v[104:107], v[68:71], v[44:47]
    ds_read_b128 v[132:135], v245 offset:3136
    v_mfma_f32_16x16x32_bf16 v[48:51], v[104:107], v[72:75], v[48:51]
    ds_read_b64_tr_b16 v[164:165], v246 offset:576
    v_mfma_f32_16x16x32_bf16 v[44:47], v[96:99], v[76:79], v[44:47]
    ds_read_b64_tr_b16 v[166:167], v246 offset:584
    v_mfma_f32_16x16x32_bf16 v[48:51], v[100:103], v[76:79], v[48:51]
    ds_read_b128 v[136:139], v245 offset:2624
    v_mfma_f32_16x16x32_bf16 v[52:55], v[104:107], v[76:79], v[52:55]
    ds_read_b64_tr_b16 v[168:169], v246 offset:1088
    v_mfma_f32_16x16x32_bf16 v[44:47], v[108:111], v[64:67], v[44:47]
    s_waitcnt lgkmcnt(8)
    ds_read_b64_tr_b16 v[170:171], v246 offset:1096
    v_mfma_f32_16x16x32_bf16 v[48:51], v[108:111], v[68:71], v[48:51]
    ds_read_b128 v[140:143], v245 offset:2112
    v_mfma_f32_16x16x32_bf16 v[52:55], v[108:111], v[72:75], v[52:55]
    ds_read_b64_tr_b16 v[172:173], v246 offset:1600
    v_mfma_f32_16x16x32_bf16 v[56:59], v[108:111], v[76:79], v[56:59]
    ds_read_b64_tr_b16 v[174:175], v246 offset:1608
    v_mfma_f32_16x16x32_bf16 v[48:51], v[96:99], v[80:83], v[48:51]
    ds_read_b128 v[144:147], v245 offset:1600
    v_mfma_f32_16x16x32_bf16 v[52:55], v[100:103], v[80:83], v[52:55]
    ds_read_b64_tr_b16 v[176:177], v246 offset:2112
    v_mfma_f32_16x16x32_bf16 v[56:59], v[104:107], v[80:83], v[56:59]
    s_waitcnt lgkmcnt(8)
    ds_read_b64_tr_b16 v[178:179], v246 offset:2120
    v_mfma_f32_16x16x32_bf16 v[60:63], v[108:111], v[80:83], v[60:63]
    ds_read_b128 v[148:151], v245 offset:1088
    v_mfma_f32_16x16x32_bf16 v[48:51], v[112:115], v[64:67], v[48:51]
    ds_read_b64_tr_b16 v[180:181], v246 offset:2624
    v_mfma_f32_16x16x32_bf16 v[52:55], v[112:115], v[68:71], v[52:55]
    ds_read_b64_tr_b16 v[182:183], v246 offset:2632
    v_mfma_f32_16x16x32_bf16 v[56:59], v[112:115], v[72:75], v[56:59]
    ds_read_b128 v[152:155], v245 offset:576
    v_mfma_f32_16x16x32_bf16 v[60:63], v[112:115], v[76:79], v[60:63]
    ds_read_b64_tr_b16 v[184:185], v246 offset:3136
    v_mfma_f32_16x16x32_bf16 v[52:55], v[96:99], v[84:87], v[52:55]
    s_waitcnt lgkmcnt(8)
    ds_read_b64_tr_b16 v[186:187], v246 offset:3144
    v_mfma_f32_16x16x32_bf16 v[56:59], v[100:103], v[84:87], v[56:59]
    ds_read_b128 v[156:159], v245 offset:64
    v_mfma_f32_16x16x32_bf16 v[60:63], v[104:107], v[84:87], v[60:63]
    ds_read_b64_tr_b16 v[188:189], v246 offset:3648
    v_mfma_f32_16x16x32_bf16 v[52:55], v[116:119], v[64:67], v[52:55]
    ds_read_b64_tr_b16 v[190:191], v246 offset:3656
    v_mfma_f32_16x16x32_bf16 v[56:59], v[116:119], v[68:71], v[56:59]
    v_mfma_f32_16x16x32_bf16 v[60:63], v[116:119], v[72:75], v[60:63]
    v_mfma_f32_16x16x32_bf16 v[56:59], v[96:99], v[88:91], v[56:59]
    v_mfma_f32_16x16x32_bf16 v[60:63], v[100:103], v[88:91], v[60:63]
    v_mfma_f32_16x16x32_bf16 v[56:59], v[120:123], v[64:67], v[56:59]
    v_mfma_f32_16x16x32_bf16 v[60:63], v[120:123], v[68:71], v[60:63]
    v_mfma_f32_16x16x32_bf16 v[60:63], v[96:99], v[92:95], v[60:63]
    v_mfma_f32_16x16x32_bf16 v[60:63], v[124:127], v[64:67], v[60:63]
    v_mfma_f32_16x16x32_bf16 v[32:35], v[160:163], v[128:131], v[32:35]
    ds_read_b128 v[64:67], v245 offset:3712
    v_mfma_f32_16x16x32_bf16 v[36:39], v[160:163], v[132:135], v[36:39]
    ds_read_b64_tr_b16 v[96:97], v246 offset:128
    v_mfma_f32_16x16x32_bf16 v[36:39], v[164:167], v[128:131], v[36:39]
    s_waitcnt lgkmcnt(8)
    ds_read_b64_tr_b16 v[98:99], v246 offset:136
    v_mfma_f32_16x16x32_bf16 v[40:43], v[164:167], v[132:135], v[40:43]
    ds_read_b128 v[68:71], v245 offset:3200
    v_mfma_f32_16x16x32_bf16 v[40:43], v[160:163], v[136:139], v[40:43]
    ds_read_b64_tr_b16 v[100:101], v246 offset:640
    v_mfma_f32_16x16x32_bf16 v[44:47], v[164:167], v[136:139], v[44:47]
    ds_read_b64_tr_b16 v[102:103], v246 offset:648
    v_mfma_f32_16x16x32_bf16 v[40:43], v[168:171], v[128:131], v[40:43]
    ds_read_b128 v[72:75], v245 offset:2688
    v_mfma_f32_16x16x32_bf16 v[44:47], v[168:171], v[132:135], v[44:47]
    ds_read_b64_tr_b16 v[104:105], v246 offset:1152
    v_mfma_f32_16x16x32_bf16 v[48:51], v[168:171], v[136:139], v[48:51]
    s_waitcnt lgkmcnt(8)
    ds_read_b64_tr_b16 v[106:107], v246 offset:1160
    v_mfma_f32_16x16x32_bf16 v[44:47], v[160:163], v[140:143], v[44:47]
    ds_read_b128 v[76:79], v245 offset:2176
    v_mfma_f32_16x16x32_bf16 v[48:51], v[164:167], v[140:143], v[48:51]
    ds_read_b64_tr_b16 v[108:109], v246 offset:1664
    v_mfma_f32_16x16x32_bf16 v[52:55], v[168:171], v[140:143], v[52:55]
    ds_read_b64_tr_b16 v[110:111], v246 offset:1672
    v_mfma_f32_16x16x32_bf16 v[44:47], v[172:175], v[128:131], v[44:47]
    ds_read_b128 v[80:83], v245 offset:1664
    v_mfma_f32_16x16x32_bf16 v[48:51], v[172:175], v[132:135], v[48:51]
    ds_read_b64_tr_b16 v[112:113], v246 offset:2176
    v_mfma_f32_16x16x32_bf16 v[52:55], v[172:175], v[136:139], v[52:55]
    s_waitcnt lgkmcnt(8)
    ds_read_b64_tr_b16 v[114:115], v246 offset:2184
    v_mfma_f32_16x16x32_bf16 v[56:59], v[172:175], v[140:143], v[56:59]
    ds_read_b128 v[84:87], v245 offset:1152
    v_mfma_f32_16x16x32_bf16 v[48:51], v[160:163], v[144:147], v[48:51]
    ds_read_b64_tr_b16 v[116:117], v246 offset:2688
    v_mfma_f32_16x16x32_bf16 v[52:55], v[164:167], v[144:147], v[52:55]
    ds_read_b64_tr_b16 v[118:119], v246 offset:2696
    v_mfma_f32_16x16x32_bf16 v[56:59], v[168:171], v[144:147], v[56:59]
    ds_read_b128 v[88:91], v245 offset:640
    v_mfma_f32_16x16x32_bf16 v[60:63], v[172:175], v[144:147], v[60:63]
    ds_read_b64_tr_b16 v[120:121], v246 offset:3200
    v_mfma_f32_16x16x32_bf16 v[48:51], v[176:179], v[128:131], v[48:51]
    s_waitcnt lgkmcnt(8)
    ds_read_b64_tr_b16 v[122:123], v246 offset:3208
    v_mfma_f32_16x16x32_bf16 v[52:55], v[176:179], v[132:135], v[52:55]
    ds_read_b128 v[92:95], v245 offset:128
    v_mfma_f32_16x16x32_bf16 v[56:59], v[176:179], v[136:139], v[56:59]
    ds_read_b64_tr_b16 v[124:125], v246 offset:3712
    v_mfma_f32_16x16x32_bf16 v[60:63], v[176:179], v[140:143], v[60:63]
    ds_read_b64_tr_b16 v[126:127], v246 offset:3720
    v_mfma_f32_16x16x32_bf16 v[52:55], v[160:163], v[148:151], v[52:55]
    v_mfma_f32_16x16x32_bf16 v[56:59], v[164:167], v[148:151], v[56:59]
    v_mfma_f32_16x16x32_bf16 v[60:63], v[168:171], v[148:151], v[60:63]
    v_mfma_f32_16x16x32_bf16 v[52:55], v[180:183], v[128:131], v[52:55]
    v_mfma_f32_16x16x32_bf16 v[56:59], v[180:183], v[132:135], v[56:59]
    v_mfma_f32_16x16x32_bf16 v[60:63], v[180:183], v[136:139], v[60:63]
    v_mfma_f32_16x16x32_bf16 v[56:59], v[160:163], v[152:155], v[56:59]
    v_mfma_f32_16x16x32_bf16 v[60:63], v[164:167], v[152:155], v[60:63]
    v_mfma_f32_16x16x32_bf16 v[56:59], v[184:187], v[128:131], v[56:59]
    v_mfma_f32_16x16x32_bf16 v[60:63], v[184:187], v[132:135], v[60:63]
    v_mfma_f32_16x16x32_bf16 v[60:63], v[160:163], v[156:159], v[60:63]
    v_mfma_f32_16x16x32_bf16 v[60:63], v[188:191], v[128:131], v[60:63]
    v_mfma_f32_16x16x32_bf16 v[32:35], v[96:99], v[64:67], v[32:35]
    ds_read_b128 v[128:131], v245 offset:3776
    v_mfma_f32_16x16x32_bf16 v[36:39], v[96:99], v[68:71], v[36:39]
    ds_read_b64_tr_b16 v[160:161], v246 offset:192
    v_mfma_f32_16x16x32_bf16 v[36:39], v[100:103], v[64:67], v[36:39]
    s_waitcnt lgkmcnt(8)
    ds_read_b64_tr_b16 v[162:163], v246 offset:200
    v_mfma_f32_16x16x32_bf16 v[40:43], v[100:103], v[68:71], v[40:43]
    ds_read_b128 v[132:135], v245 offset:3264
    v_mfma_f32_16x16x32_bf16 v[40:43], v[96:99], v[72:75], v[40:43]
    ds_read_b64_tr_b16 v[164:165], v246 offset:704
    v_mfma_f32_16x16x32_bf16 v[44:47], v[100:103], v[72:75], v[44:47]
    ds_read_b64_tr_b16 v[166:167], v246 offset:712
    v_mfma_f32_16x16x32_bf16 v[40:43], v[104:107], v[64:67], v[40:43]
    ds_read_b128 v[136:139], v245 offset:2752
    v_mfma_f32_16x16x32_bf16 v[44:47], v[104:107], v[68:71], v[44:47]
    ds_read_b64_tr_b16 v[168:169], v246 offset:1216
    v_mfma_f32_16x16x32_bf16 v[48:51], v[104:107], v[72:75], v[48:51]
    s_waitcnt lgkmcnt(8)
    ds_read_b64_tr_b16 v[170:171], v246 offset:1224
    v_mfma_f32_16x16x32_bf16 v[44:47], v[96:99], v[76:79], v[44:47]
    ds_read_b128 v[140:143], v245 offset:2240
    v_mfma_f32_16x16x32_bf16 v[48:51], v[100:103], v[76:79], v[48:51]
    ds_read_b64_tr_b16 v[172:173], v246 offset:1728
    v_mfma_f32_16x16x32_bf16 v[52:55], v[104:107], v[76:79], v[52:55]
    ds_read_b64_tr_b16 v[174:175], v246 offset:1736
    v_mfma_f32_16x16x32_bf16 v[44:47], v[108:111], v[64:67], v[44:47]
    ds_read_b128 v[144:147], v245 offset:1728
    v_mfma_f32_16x16x32_bf16 v[48:51], v[108:111], v[68:71], v[48:51]
    ds_read_b64_tr_b16 v[176:177], v246 offset:2240
    v_mfma_f32_16x16x32_bf16 v[52:55], v[108:111], v[72:75], v[52:55]
    s_waitcnt lgkmcnt(8)
    ds_read_b64_tr_b16 v[178:179], v246 offset:2248
    v_mfma_f32_16x16x32_bf16 v[56:59], v[108:111], v[76:79], v[56:59]
    ds_read_b128 v[148:151], v245 offset:1216
    v_mfma_f32_16x16x32_bf16 v[48:51], v[96:99], v[80:83], v[48:51]
    ds_read_b64_tr_b16 v[180:181], v246 offset:2752
    v_mfma_f32_16x16x32_bf16 v[52:55], v[100:103], v[80:83], v[52:55]
    ds_read_b64_tr_b16 v[182:183], v246 offset:2760
    v_mfma_f32_16x16x32_bf16 v[56:59], v[104:107], v[80:83], v[56:59]
    ds_read_b128 v[152:155], v245 offset:704
    v_mfma_f32_16x16x32_bf16 v[60:63], v[108:111], v[80:83], v[60:63]
    ds_read_b64_tr_b16 v[184:185], v246 offset:3264
    v_mfma_f32_16x16x32_bf16 v[48:51], v[112:115], v[64:67], v[48:51]
    s_waitcnt lgkmcnt(8)
    ds_read_b64_tr_b16 v[186:187], v246 offset:3272
    v_mfma_f32_16x16x32_bf16 v[52:55], v[112:115], v[68:71], v[52:55]
    ds_read_b128 v[156:159], v245 offset:192
    v_mfma_f32_16x16x32_bf16 v[56:59], v[112:115], v[72:75], v[56:59]
    ds_read_b64_tr_b16 v[188:189], v246 offset:3776
    v_mfma_f32_16x16x32_bf16 v[60:63], v[112:115], v[76:79], v[60:63]
    ds_read_b64_tr_b16 v[190:191], v246 offset:3784
    v_mfma_f32_16x16x32_bf16 v[52:55], v[96:99], v[84:87], v[52:55]
    v_mfma_f32_16x16x32_bf16 v[56:59], v[100:103], v[84:87], v[56:59]
    v_mfma_f32_16x16x32_bf16 v[60:63], v[104:107], v[84:87], v[60:63]
    v_mfma_f32_16x16x32_bf16 v[52:55], v[116:119], v[64:67], v[52:55]
    v_mfma_f32_16x16x32_bf16 v[56:59], v[116:119], v[68:71], v[56:59]
    v_mfma_f32_16x16x32_bf16 v[60:63], v[116:119], v[72:75], v[60:63]
    v_mfma_f32_16x16x32_bf16 v[56:59], v[96:99], v[88:91], v[56:59]
    v_mfma_f32_16x16x32_bf16 v[60:63], v[100:103], v[88:91], v[60:63]
    v_mfma_f32_16x16x32_bf16 v[56:59], v[120:123], v[64:67], v[56:59]
    v_mfma_f32_16x16x32_bf16 v[60:63], v[120:123], v[68:71], v[60:63]
    v_mfma_f32_16x16x32_bf16 v[60:63], v[96:99], v[92:95], v[60:63]
    v_mfma_f32_16x16x32_bf16 v[60:63], v[124:127], v[64:67], v[60:63]
    v_mfma_f32_16x16x32_bf16 v[32:35], v[160:163], v[128:131], v[32:35]
    ds_read_b32 v192, v252 offset:12504
    v_mfma_f32_16x16x32_bf16 v[36:39], v[160:163], v[132:135], v[36:39]
    ds_read_b32 v193, v252 offset:29144
    v_mfma_f32_16x16x32_bf16 v[36:39], v[164:167], v[128:131], v[36:39]
    s_waitcnt lgkmcnt(8)
    ds_read_b32 v194, v252 offset:12760
    v_mfma_f32_16x16x32_bf16 v[40:43], v[164:167], v[132:135], v[40:43]
    ds_read_b32 v195, v252 offset:29400
    v_mfma_f32_16x16x32_bf16 v[40:43], v[160:163], v[136:139], v[40:43]
    ds_read_b32 v196, v252 offset:13016
    v_mfma_f32_16x16x32_bf16 v[44:47], v[164:167], v[136:139], v[44:47]
    ds_read_b32 v197, v252 offset:29656
    v_mfma_f32_16x16x32_bf16 v[40:43], v[168:171], v[128:131], v[40:43]
    ds_read_b32 v198, v252 offset:13272
    v_mfma_f32_16x16x32_bf16 v[44:47], v[168:171], v[132:135], v[44:47]
    ds_read_b32 v199, v252 offset:29912
    v_mov_b32 v21, 1
    s_mov_b64 exec, 1
    ds_add_u32 v253, v21 offset:12
    s_mov_b64 exec, -1
    v_mfma_f32_16x16x32_bf16 v[48:51], v[168:171], v[136:139], v[48:51]
    v_mfma_f32_16x16x32_bf16 v[44:47], v[160:163], v[140:143], v[44:47]
    v_mfma_f32_16x16x32_bf16 v[48:51], v[164:167], v[140:143], v[48:51]
    v_mfma_f32_16x16x32_bf16 v[52:55], v[168:171], v[140:143], v[52:55]
    v_mfma_f32_16x16x32_bf16 v[44:47], v[172:175], v[128:131], v[44:47]
    v_mfma_f32_16x16x32_bf16 v[48:51], v[172:175], v[132:135], v[48:51]
    v_mfma_f32_16x16x32_bf16 v[52:55], v[172:175], v[136:139], v[52:55]
    v_mfma_f32_16x16x32_bf16 v[56:59], v[172:175], v[140:143], v[56:59]
    v_mfma_f32_16x16x32_bf16 v[48:51], v[160:163], v[144:147], v[48:51]
    v_mfma_f32_16x16x32_bf16 v[52:55], v[164:167], v[144:147], v[52:55]
    v_mfma_f32_16x16x32_bf16 v[56:59], v[168:171], v[144:147], v[56:59]
    v_mfma_f32_16x16x32_bf16 v[60:63], v[172:175], v[144:147], v[60:63]
    v_mfma_f32_16x16x32_bf16 v[48:51], v[176:179], v[128:131], v[48:51]
    v_mfma_f32_16x16x32_bf16 v[52:55], v[176:179], v[132:135], v[52:55]
    v_mfma_f32_16x16x32_bf16 v[56:59], v[176:179], v[136:139], v[56:59]
    v_mfma_f32_16x16x32_bf16 v[60:63], v[176:179], v[140:143], v[60:63]
    v_mfma_f32_16x16x32_bf16 v[52:55], v[160:163], v[148:151], v[52:55]
    v_mfma_f32_16x16x32_bf16 v[56:59], v[164:167], v[148:151], v[56:59]
    v_mfma_f32_16x16x32_bf16 v[60:63], v[168:171], v[148:151], v[60:63]
    v_mfma_f32_16x16x32_bf16 v[52:55], v[180:183], v[128:131], v[52:55]
    v_mfma_f32_16x16x32_bf16 v[56:59], v[180:183], v[132:135], v[56:59]
    v_mfma_f32_16x16x32_bf16 v[60:63], v[180:183], v[136:139], v[60:63]
    s_waitcnt lgkmcnt(12)
    v_mfma_f32_16x16x32_bf16 v[56:59], v[160:163], v[152:155], v[56:59]
    v_mfma_f32_16x16x32_bf16 v[60:63], v[164:167], v[152:155], v[60:63]
    v_mfma_f32_16x16x32_bf16 v[56:59], v[184:187], v[128:131], v[56:59]
    v_mfma_f32_16x16x32_bf16 v[60:63], v[184:187], v[132:135], v[60:63]
    s_waitcnt lgkmcnt(9)
    v_mfma_f32_16x16x32_bf16 v[60:63], v[160:163], v[156:159], v[60:63]
    v_mfma_f32_16x16x32_bf16 v[60:63], v[188:191], v[128:131], v[60:63]
    s_lshl_b32 s32, s7, 14
    s_lshl_b32 s30, s5, 12
    s_add_u32 s32, s32, s30
    s_add_u32 s32, s32, 10485760
    v_xor_b32 v23, 128, v251
    s_mov_b32 s42, 1600000
Ll_cvd:
    ds_read_b32 v21, v253 offset:12
    s_waitcnt lgkmcnt(0)
    v_readfirstlane_b32 s3, v21
    s_sub_u32 s42, s42, 1
    s_cbranch_scc1 Ll_cvd_ok
    s_cmp_ge_u32 s3, 4
    s_cbranch_scc1 Ll_cvd_ok
    s_sleep 1
    s_branch Ll_cvd
Ll_cvd_ok:
    ds_write_b128 v250, v[32:35] offset:0
    ds_write_b128 v250, v[36:39] offset:1024
    ds_write_b128 v250, v[40:43] offset:2048
    ds_write_b128 v250, v[44:47] offset:3072
    ds_write_b128 v250, v[48:51] offset:4096
    ds_write_b128 v250, v[52:55] offset:5120
    ds_write_b128 v250, v[56:59] offset:6144
    ds_write_b128 v250, v[60:63] offset:7168
    v_mov_b32 v21, 1
    s_mov_b64 exec, 1
    ds_add_u32 v253, v21 offset:16
    s_mov_b64 exec, -1
    v_lshlrev_b32 v200, 16, v192
    v_and_b32 v201, 0xffff0000, v192
    v_lshlrev_b32 v202, 16, v193
    v_and_b32 v203, 0xffff0000, v193
    v_lshlrev_b32 v204, 16, v194
    v_and_b32 v205, 0xffff0000, v194
    v_lshlrev_b32 v206, 16, v195
    v_and_b32 v207, 0xffff0000, v195
    v_lshlrev_b32 v208, 16, v196
    v_and_b32 v209, 0xffff0000, v196
    v_lshlrev_b32 v210, 16, v197
    v_and_b32 v211, 0xffff0000, v197
    v_lshlrev_b32 v212, 16, v198
    v_and_b32 v213, 0xffff0000, v198
    v_lshlrev_b32 v214, 16, v199
    v_and_b32 v215, 0xffff0000, v199
    s_mov_b32 s42, 1600000
Ll_part:
    ds_read_b32 v21, v253 offset:16
    s_waitcnt lgkmcnt(0)
    v_readfirstlane_b32 s3, v21
    s_sub_u32 s42, s42, 1
    s_cbranch_scc1 Ll_part_ok
    s_cmp_ge_u32 s3, 4
    s_cbranch_scc1 Ll_part_ok
    s_sleep 1
    s_branch Ll_part
Ll_part_ok:
    ds_read_b64 v[64:65], v251 offset:0
    ds_read_b64 v[66:67], v251 offset:16384
    ds_read_b64 v[68:69], v251 offset:8192
    ds_read_b64 v[70:71], v251 offset:24576
    ds_read_b64 v[72:73], v23 offset:0
    ds_read_b64 v[74:75], v23 offset:16384
    ds_read_b64 v[76:77], v23 offset:8192
    ds_read_b64 v[78:79], v23 offset:24576
    ds_read_b64 v[80:81], v251 offset:1024
    ds_read_b64 v[82:83], v251 offset:17408
    ds_read_b64 v[84:85], v251 offset:9216
    ds_read_b64 v[86:87], v251 offset:25600
    s_waitcnt lgkmcnt(8)
    ds_read_b64 v[88:89], v23 offset:1024
    ds_read_b64 v[90:91], v23 offset:17408
    ds_read_b64 v[92:93], v23 offset:9216
    ds_read_b64 v[94:95], v23 offset:25600
    s_setprio 3
    s_movk_i32 s31, 0xff
    v_lshrrev_b32_e64 v24, 0, s6
    v_lshrrev_b32_e64 v25, 8, s6
    v_lshrrev_b32_e64 v26, 16, s6
    v_lshrrev_b32_e64 v27, 24, s6
    v_add_f32 v96, v64, v66
    v_add_f32 v97, v68, v70
    v_add_f32 v98, v65, v67
    v_add_f32 v99, v69, v71
    v_fmac_f32 v96, s29, v200
    v_fmac_f32 v97, s12, v202
    v_fmac_f32 v98, s29, v201
    v_fmac_f32 v99, s12, v203
    v_bfi_b32 v96, s31, v24, v96
    v_bfi_b32 v97, s31, v25, v97
    v_bfi_b32 v98, s31, v26, v98
    v_bfi_b32 v99, s31, v27, v99
    buffer_store_dwordx4 v[96:99], v20, s[44:47], s32 offen offset:0 sc1
    s_waitcnt lgkmcnt(8)
    v_add_f32 v100, v72, v74
    v_add_f32 v101, v76, v78
    v_add_f32 v102, v73, v75
    v_add_f32 v103, v77, v79
    v_fmac_f32 v100, s29, v204
    v_fmac_f32 v101, s12, v206
    v_fmac_f32 v102, s29, v205
    v_fmac_f32 v103, s12, v207
    v_bfi_b32 v100, s31, v24, v100
    v_bfi_b32 v101, s31, v25, v101
    v_bfi_b32 v102, s31, v26, v102
    v_bfi_b32 v103, s31, v27, v103
    buffer_store_dwordx4 v[100:103], v20, s[44:47], s32 offen offset:1024 sc1
    s_waitcnt lgkmcnt(4)
    v_add_f32 v104, v80, v82
    v_add_f32 v105, v84, v86
    v_add_f32 v106, v81, v83
    v_add_f32 v107, v85, v87
    v_fmac_f32 v104, s29, v208
    v_fmac_f32 v105, s12, v210
    v_fmac_f32 v106, s29, v209
    v_fmac_f32 v107, s12, v211
    v_bfi_b32 v104, s31, v24, v104
    v_bfi_b32 v105, s31, v25, v105
    v_bfi_b32 v106, s31, v26, v106
    v_bfi_b32 v107, s31, v27, v107
    buffer_store_dwordx4 v[104:107], v20, s[44:47], s32 offen offset:2048 sc1
    s_waitcnt lgkmcnt(0)
    v_add_f32 v108, v88, v90
    v_add_f32 v109, v92, v94
    v_add_f32 v110, v89, v91
    v_add_f32 v111, v93, v95
    v_fmac_f32 v108, s29, v212
    v_fmac_f32 v109, s12, v214
    v_fmac_f32 v110, s29, v213
    v_fmac_f32 v111, s12, v215
    v_bfi_b32 v108, s31, v24, v108
    v_bfi_b32 v109, s31, v25, v109
    v_bfi_b32 v110, s31, v26, v110
    v_bfi_b32 v111, s31, v27, v111
    buffer_store_dwordx4 v[108:111], v20, s[44:47], s32 offen offset:3072 sc1
    s_endpgm
.p2align 6
Lrole_m:
    s_cmp_eq_u32 s5, 3
    s_cselect_b32 s44, 0, s5
    s_add_u32 s45, s44, 1
    s_cmp_eq_u32 s45, 3
    s_cselect_b32 s45, 0, s45
    s_add_u32 s46, s45, 1
    s_cmp_eq_u32 s46, 3
    s_cselect_b32 s46, 0, s46
    v_lshrrev_b32 v30, 4, v1
    v_and_b32 v19, 31, v1
    v_bfe_u32 v31, v1, 1, 3
    v_lshrrev_b32 v11, 5, v1
    v_xor_b32 v31, v31, v11
    v_lshlrev_b32 v31, 4, v31
    v_lshl_add_u32 v31, v19, 7, v31
    s_add_u32 s3, s52, 12288
    v_add_u32 v12, s3, v31
    v_xor_b32 v13, 32, v12
    v_xor_b32 v14, 64, v12
    v_xor_b32 v15, 96, v12
    v_bfe_u32 v3, v1, 2, 2
    v_lshl_add_u32 v2, v11, 3, v3
    v_mul_u32_u24 v2, 192, v2
    v_and_b32 v31, 1, v30
    v_lshl_add_u32 v2, v31, 5, v2
    v_and_b32 v29, 3, v1
    v_lshl_add_u32 v2, v29, 3, v2
    v_lshl_add_u32 v16, s44, 6, v2
    v_lshl_add_u32 v17, s45, 6, v2
    v_lshl_add_u32 v18, s46, 6, v2
    v_add_u32 v4, 57344, v16
    v_add_u32 v5, 57344, v17
    v_add_u32 v6, 57344, v18
    v_lshl_add_u32 v2, v11, 2, v3
    v_lshlrev_b32 v2, 7, v2
    v_xor_b32 v31, s5, v31
    v_and_b32 v8, 2, v3
    v_xor_b32 v31, v31, v8
    v_lshl_add_u32 v2, v31, 5, v2
    v_lshl_add_u32 v2, v29, 3, v2
    v_add_u32 v240, s52, v2
    v_xor_b32 v241, 64, v240
    v_add_u32 v242, 65536, v240
    v_add_u32 v243, 65536, v241
    v_add_u32 v244, 119296, v240
    v_add_u32 v245, 119296, v241
    v_mul_u32_u24 v138, 1088, v3
    v_xor_b32 v3, v3, v30
    v_and_b32 v3, 1, v3
    v_cmp_eq_u32 vcc, 0, v3
    v_mov_b32 v31, 0x3f803f80
    s_mul_i32 s3, s5, 2176
    s_add_u32 s3, s3, 153088
    v_lshl_add_u32 v137, v1, 4, s3
    v_cndmask_b32 v20, 0, v31, vcc
    v_cndmask_b32 v21, 0, v31, vcc
    v_cndmask_b32 v22, 0, v31, vcc
    v_cndmask_b32 v23, 0, v31, vcc
    v_lshl_add_u32 v138, v30, 5, v138
    v_lshl_add_u32 v138, v29, 3, v138
    s_lshl_b32 s3, s5, 8
    s_add_u32 s3, s3, 153088
    v_add_u32 v138, s3, v138
    v_lshrrev_b32 v2, 3, v1
    v_and_b32 v3, 7, v1
    v_bfe_u32 v8, v1, 4, 1
    v_lshlrev_b32 v8, 2, v8
    v_xor_b32 v3, v3, v8
    v_lshlrev_b32 v3, 4, v3
    v_lshl_add_u32 v3, v2, 10, v3
    s_lshl_b32 s3, s49, 7
    v_add_u32 v252, s3, v3
    v_add_u32 v253, 7168, v252
    v_add_u32 v254, 14336, v252
    v_add_u32 v255, 21504, v252
    s_mul_i32 s50, s5, 360448
    v_mov_b32 v60, 0x3b000000
    s_waitcnt vmcnt(0)
    v_readfirstlane_b32 s6, v115
    v_lshlrev_b32 v32, 16, v140
    v_and_b32 v33, 0xffff0000, v140
    v_lshlrev_b32 v34, 16, v141
    v_and_b32 v35, 0xffff0000, v141
    v_lshlrev_b32 v36, 16, v142
    v_and_b32 v37, 0xffff0000, v142
    v_lshlrev_b32 v38, 16, v143
    v_and_b32 v39, 0xffff0000, v143
    v_lshlrev_b32 v40, 16, v144
    v_and_b32 v41, 0xffff0000, v144
    v_lshlrev_b32 v42, 16, v145
    v_and_b32 v43, 0xffff0000, v145
    v_lshlrev_b32 v44, 16, v146
    v_and_b32 v45, 0xffff0000, v146
    v_lshlrev_b32 v46, 16, v147
    v_and_b32 v47, 0xffff0000, v147
    s_or_b32 s6, s6, 1
    s_add_u32 s6, s6, 0x9e3779b2
    v_pk_add_f32 v[48:49], v[32:33], v[34:35]
    v_pk_mul_f32 v[50:51], v[32:33], v[32:33]
    v_pk_add_f32 v[52:53], v[40:41], v[42:43]
    v_pk_mul_f32 v[54:55], v[40:41], v[40:41]
    v_pk_fma_f32 v[50:51], v[34:35], v[34:35], v[50:51]
    v_pk_fma_f32 v[54:55], v[42:43], v[42:43], v[54:55]
    v_pk_add_f32 v[48:49], v[48:49], v[36:37]
    v_pk_fma_f32 v[50:51], v[36:37], v[36:37], v[50:51]
    v_pk_add_f32 v[52:53], v[52:53], v[44:45]
    v_pk_fma_f32 v[54:55], v[44:45], v[44:45], v[54:55]
    v_pk_add_f32 v[48:49], v[48:49], v[38:39]
    v_pk_fma_f32 v[50:51], v[38:39], v[38:39], v[50:51]
    v_pk_add_f32 v[52:53], v[52:53], v[46:47]
    v_pk_fma_f32 v[54:55], v[46:47], v[46:47], v[54:55]
    v_add_f32 v56, v48, v49
    v_add_f32 v57, v50, v51
    v_add_f32 v58, v52, v53
    v_add_f32 v59, v54, v55
    v_add_f32_dpp v56, v56, v56 row_shr:1 row_mask:0xf bank_mask:0xf bound_ctrl:0
    v_add_f32_dpp v57, v57, v57 row_shr:1 row_mask:0xf bank_mask:0xf bound_ctrl:0
    v_add_f32_dpp v58, v58, v58 row_shr:1 row_mask:0xf bank_mask:0xf bound_ctrl:0
    v_add_f32_dpp v59, v59, v59 row_shr:1 row_mask:0xf bank_mask:0xf bound_ctrl:0
    v_add_f32_dpp v56, v56, v56 row_shr:2 row_mask:0xf bank_mask:0xf bound_ctrl:0
    v_add_f32_dpp v57, v57, v57 row_shr:2 row_mask:0xf bank_mask:0xf bound_ctrl:0
    v_add_f32_dpp v58, v58, v58 row_shr:2 row_mask:0xf bank_mask:0xf bound_ctrl:0
    v_add_f32_dpp v59, v59, v59 row_shr:2 row_mask:0xf bank_mask:0xf bound_ctrl:0
    v_add_f32_dpp v56, v56, v56 row_shr:4 row_mask:0xf bank_mask:0xf bound_ctrl:0
    v_add_f32_dpp v57, v57, v57 row_shr:4 row_mask:0xf bank_mask:0xf bound_ctrl:0
    v_add_f32_dpp v58, v58, v58 row_shr:4 row_mask:0xf bank_mask:0xf bound_ctrl:0
    v_add_f32_dpp v59, v59, v59 row_shr:4 row_mask:0xf bank_mask:0xf bound_ctrl:0
    v_add_f32_dpp v56, v56, v56 row_shr:8 row_mask:0xf bank_mask:0xf bound_ctrl:0
    v_add_f32_dpp v57, v57, v57 row_shr:8 row_mask:0xf bank_mask:0xf bound_ctrl:0
    v_add_f32_dpp v58, v58, v58 row_shr:8 row_mask:0xf bank_mask:0xf bound_ctrl:0
    v_add_f32_dpp v59, v59, v59 row_shr:8 row_mask:0xf bank_mask:0xf bound_ctrl:0
    v_add_f32_dpp v56, v56, v56 row_bcast:15 row_mask:0xa bank_mask:0xf
    v_add_f32_dpp v57, v57, v57 row_bcast:15 row_mask:0xa bank_mask:0xf
    v_add_f32_dpp v58, v58, v58 row_bcast:15 row_mask:0xa bank_mask:0xf
    v_add_f32_dpp v59, v59, v59 row_bcast:15 row_mask:0xa bank_mask:0xf
    v_add_f32_dpp v56, v56, v56 row_bcast:31 row_mask:0xc bank_mask:0xf
    v_add_f32_dpp v57, v57, v57 row_bcast:31 row_mask:0xc bank_mask:0xf
    v_add_f32_dpp v58, v58, v58 row_bcast:31 row_mask:0xc bank_mask:0xf
    v_add_f32_dpp v59, v59, v59 row_bcast:31 row_mask:0xc bank_mask:0xf
    v_readlane_b32 s56, v56, 63
    v_readlane_b32 s57, v57, 63
    v_readlane_b32 s58, v58, 63
    v_readlane_b32 s59, v59, 63
    v_mul_f32 v48, s56, v60
    v_mul_f32 v50, s57, v60
    v_mul_f32 v49, s58, v60
    v_mul_f32 v51, s59, v60
    v_fma_f32 v50, -v48, v48, v50
    v_fma_f32 v51, -v49, v49, v51
    v_max_f32 v50, 0, v50
    v_max_f32 v51, 0, v51
    v_cvt_pk_bf16_f32 v52, v48, v50
    v_cvt_pk_bf16_f32 v53, v49, v51
    v_and_b32 v50, 0xffff0000, v52
    v_and_b32 v51, 0xffff0000, v53
    v_add_f32 v50, 0x3727c5ac, v50
    v_add_f32 v51, 0x3727c5ac, v51
    v_cvt_pk_bf16_f32 v54, v50, v51
    v_lshlrev_b32 v50, 16, v54
    v_and_b32 v51, 0xffff0000, v54
    v_sqrt_f32 v50, v50
    v_sqrt_f32 v51, v51
    v_lshlrev_b32 v48, 16, v52
    v_lshlrev_b32 v49, 16, v53
    v_cvt_pk_bf16_f32 v148, v48, v50
    v_mov_b32 v149, s6
    v_cvt_pk_bf16_f32 v150, v49, v51
    v_mov_b32 v151, s6
    v_and_b32 v50, 0xffff0000, v148
    v_and_b32 v51, 0xffff0000, v150
    v_rcp_f32 v62, v50
    v_rcp_f32 v64, v51
    s_lshl_b32 s3, s5, 4
    s_add_u32 s3, s3, 153088
    v_mov_b32 v139, s3
    s_mov_b64 exec, 1
    ds_write_b128 v139, v[148:151] offset:8704
    ds_write_b32 v250, v149 offset:40
    s_mov_b64 exec, -1
    v_mul_f32_e64 v63, -v48, v62
    v_mul_f32_e64 v65, -v49, v64
    v_pk_fma_f32 v[32:33], v[32:33], v[62:63], v[62:63] op_sel:[0,0,1] op_sel_hi:[1,0,1]
    v_pk_fma_f32 v[34:35], v[34:35], v[62:63], v[62:63] op_sel:[0,0,1] op_sel_hi:[1,0,1]
    v_pk_fma_f32 v[36:37], v[36:37], v[62:63], v[62:63] op_sel:[0,0,1] op_sel_hi:[1,0,1]
    v_pk_fma_f32 v[38:39], v[38:39], v[62:63], v[62:63] op_sel:[0,0,1] op_sel_hi:[1,0,1]
    v_cvt_pk_bf16_f32 v140, v32, v33
    v_cvt_pk_bf16_f32 v141, v34, v35
    v_cvt_pk_bf16_f32 v142, v36, v37
    v_cvt_pk_bf16_f32 v143, v38, v39
    ds_write_b128 v137, v[140:143] offset:0
    v_pk_fma_f32 v[40:41], v[40:41], v[64:65], v[64:65] op_sel:[0,0,1] op_sel_hi:[1,0,1]
    v_pk_fma_f32 v[42:43], v[42:43], v[64:65], v[64:65] op_sel:[0,0,1] op_sel_hi:[1,0,1]
    v_pk_fma_f32 v[44:45], v[44:45], v[64:65], v[64:65] op_sel:[0,0,1] op_sel_hi:[1,0,1]
    v_pk_fma_f32 v[46:47], v[46:47], v[64:65], v[64:65] op_sel:[0,0,1] op_sel_hi:[1,0,1]
    v_cvt_pk_bf16_f32 v144, v40, v41
    v_cvt_pk_bf16_f32 v145, v42, v43
    v_cvt_pk_bf16_f32 v146, v44, v45
    v_cvt_pk_bf16_f32 v147, v46, v47
    ds_write_b128 v137, v[144:147] offset:1088
    v_mov_b32 v251, 1
    s_mov_b64 exec, 1
    ds_add_u32 v250, v251 offset:0
    s_mov_b64 exec, -1
    v_lshlrev_b32 v7, 4, v1
    v_add_u32 v137, 153088, v7
    s_lshl_b32 s55, s7, 7
    s_add_u32 s54, s55, 2097152
    s_lshl_b32 s55, s7, 2
    s_add_u32 s55, s55, 14712832
    s_mov_b32 s42, 1600000
Lm_ln:
    ds_read_b32 v251, v250 offset:0
    s_waitcnt lgkmcnt(0)
    v_readfirstlane_b32 s3, v251
    s_sub_u32 s42, s42, 1
    s_cbranch_scc1 Lm_ln_ok
    s_cmp_ge_u32 s3, 4
    s_cbranch_scc1 Lm_ln_ok
    s_branch Lm_ln
Lm_ln_ok:
    ds_read_b64_tr_b16 v[140:141], v138 offset:0
    ds_read_b64_tr_b16 v[142:143], v138 offset:4352
    ds_read_b64_tr_b16 v[144:145], v138 offset:128
    ds_read_b64_tr_b16 v[146:147], v138 offset:4480
    ds_read_b128 v[148:151], v137 offset:8704
    s_cmp_eq_u32 s5, 0
    s_waitcnt lgkmcnt(0)
    s_cbranch_scc0 Lm_nost
    s_mov_b64 exec, 15
    buffer_store_dwordx4 v[148:151], v7, s[20:23], s54 offen sc1
    s_mov_b64 exec, -1
Lm_nost:
    buffer_store_dwordx4 v[140:143], v136, s[20:23], 0 offen sc1
    buffer_store_dwordx4 v[144:147], v136, s[20:23], 0 offen offset:1024 sc1
    v_lshlrev_b32 v29, 1, v19
    s_mul_i32 s3, s35, 192
    s_lshl_b32 s43, s44, 6
    s_add_u32 s3, s3, s43
    buffer_load_ushort v28, v29, s[28:31], s3 offen
    s_mov_b32 s41, 1600000
    s_barrier
    ds_read_b128 v[104:107], v12 offset:28672
    ds_read_b64_tr_b16 v[80:81], v16 offset:28672
    ds_read_b64_tr_b16 v[82:83], v16 offset:29440
    ds_read_b64_tr_b16 v[84:85], v17 offset:28672
    ds_read_b64_tr_b16 v[86:87], v17 offset:29440
    ds_read_b64_tr_b16 v[88:89], v18 offset:28672
    ds_read_b64_tr_b16 v[90:91], v18 offset:29440
    v_and_b32 v114, 24, v19
    v_add_lshl_u32 v114, v114, v19, 3
    s_lshl_b32 s3, s34, 11
    s_lshl_b32 s43, s5, 9
    s_add_u32 s47, s3, s43
    s_add_u32 s47, s47, 2097152
    s_waitcnt lgkmcnt(4)
    v_mfma_f32_32x32x16_bf16 v[32:47], v[80:83], v[104:107], 0
    ds_read_b128 v[108:111], v13 offset:28672
    ds_read_b64_tr_b16 v[92:93], v16 offset:31744
    ds_read_b64_tr_b16 v[94:95], v16 offset:32512
    s_waitcnt lgkmcnt(5)
    v_mfma_f32_32x32x16_bf16 v[48:63], v[84:87], v[104:107], 0
    ds_read_b64_tr_b16 v[96:97], v17 offset:31744
    ds_read_b64_tr_b16 v[98:99], v17 offset:32512
    s_waitcnt lgkmcnt(5)
    v_mfma_f32_32x32x16_bf16 v[64:79], v[88:91], v[104:107], 0
    ds_read_b64_tr_b16 v[100:101], v18 offset:31744
    ds_read_b64_tr_b16 v[102:103], v18 offset:32512
    v_mfma_f32_16x16x32_bf16 v[24:27], v[20:23], v[80:83], 0
    s_and_b32 s3, s48, 1
    s_lshl_b32 s3, s3, 13
    s_add_u32 s3, s3, 40960
    v_bfe_u32 v2, v1, 1, 3
    v_lshl_add_u32 v3, s5, 1, v11
    v_xor_b32 v2, v2, v3
    v_lshlrev_b32 v2, 4, v2
    v_lshl_add_u32 v2, v19, 7, v2
    v_add_u32 v2, s3, v2
    ds_read_b128 v[192:195], v2
    ds_read_b128 v[196:199], v2 offset:4096
    s_waitcnt lgkmcnt(6)
    v_mfma_f32_32x32x16_bf16 v[32:47], v[92:95], v[108:111], v[32:47]
    ds_read_b128 v[104:107], v14 offset:28672
    ds_read_b64_tr_b16 v[80:81], v16 offset:34816
    ds_read_b64_tr_b16 v[82:83], v16 offset:35584
    s_waitcnt lgkmcnt(7)
    v_mfma_f32_32x32x16_bf16 v[48:63], v[96:99], v[108:111], v[48:63]
    ds_read_b64_tr_b16 v[84:85], v17 offset:34816
    ds_read_b64_tr_b16 v[86:87], v17 offset:35584
    s_waitcnt lgkmcnt(7)
    v_mfma_f32_32x32x16_bf16 v[64:79], v[100:103], v[108:111], v[64:79]
    ds_read_b64_tr_b16 v[88:89], v18 offset:34816
    ds_read_b64_tr_b16 v[90:91], v18 offset:35584
    v_mfma_f32_16x16x32_bf16 v[24:27], v[20:23], v[92:95], v[24:27]
    v_lshlrev_b32 v208, 10, v19
    v_lshl_add_u32 v208, v11, 4, v208
    s_lshl_b32 s3, s48, 16
    s_lshl_b32 s43, s49, 7
    s_lshl_b32 s40, s5, 5
    s_add_u32 s43, s43, s40
    s_add_u32 s3, s3, s43
    v_add_u32 v208, s3, v208
    v_add_u32 v209, 32768, v208
    v_lshl_add_u32 v2, v11, 3, s43
    s_lshl_b32 s3, s5, 7
    s_add_u32 s3, s3, 163328
    v_lshl_add_u32 v205, v19, 2, s3
    s_and_b32 s3, s48, 1
    s_lshl_b32 s3, s3, 8
    s_add_u32 s3, s3, 163328
    v_lshl_add_u32 v207, v19, 2, s3
    s_lshl_b32 s39, s48, 10
    s_add_u32 s39, s39, 2097152
    global_load_dwordx2 v[200:201], v2, s[32:33]
    global_load_dwordx2 v[202:203], v2, s[32:33] offset:16
    s_waitcnt lgkmcnt(4)
    v_mfma_f32_32x32x16_bf16 v[32:47], v[80:83], v[104:107], v[32:47]
    ds_read_b128 v[108:111], v15 offset:28672
    ds_read_b64_tr_b16 v[92:93], v16 offset:37888
    ds_read_b64_tr_b16 v[94:95], v16 offset:38656
    s_waitcnt lgkmcnt(5)
    v_mfma_f32_32x32x16_bf16 v[48:63], v[84:87], v[104:107], v[48:63]
    ds_read_b64_tr_b16 v[96:97], v17 offset:37888
    ds_read_b64_tr_b16 v[98:99], v17 offset:38656
    s_waitcnt lgkmcnt(5)
    v_mfma_f32_32x32x16_bf16 v[64:79], v[88:91], v[104:107], v[64:79]
    ds_read_b64_tr_b16 v[100:101], v18 offset:37888
    ds_read_b64_tr_b16 v[102:103], v18 offset:38656
    v_mfma_f32_16x16x32_bf16 v[24:27], v[20:23], v[80:83], v[24:27]
    s_lshl_b32 s3, s34, 1
    s_lshr_b32 s43, s5, 1
    s_add_u32 s3, s3, s43
    s_lshl_b32 s3, s3, 5
    s_lshl_b32 s43, s35, 1
    s_add_u32 s3, s3, s43
    s_and_b32 s43, s5, 1
    s_add_u32 s3, s3, s43
    s_lshl_b32 s3, s3, 7
    s_add_u32 s38, s3, 14811136
    s_mov_b32 s37, 0xff
    s_cmp_eq_u32 s5, 1
    s_cselect_b32 s37, 0xffc0, s37
    s_cmp_eq_u32 s5, 2
    s_cselect_b32 s37, 0x3fc000, s37
    s_cmp_eq_u32 s5, 3
    s_cselect_b32 s37, 0x3fc00000, s37
    s_lshl_b32 s36, s48, 12
    s_add_u32 s36, s36, 14811136
    v_lshlrev_b32 v246, 7, v19
    v_mov_b32 v247, s6
    v_mov_b32 v248, 0
    v_lshl_add_u32 v249, s5, 2, v250
    s_waitcnt lgkmcnt(4)
    v_mfma_f32_32x32x16_bf16 v[32:47], v[92:95], v[108:111], v[32:47]
    s_waitcnt vmcnt(3)
    s_waitcnt lgkmcnt(0)
    s_barrier
    s_cmp_eq_u32 s5, 0
    s_cbranch_scc1 Lm_pu
Lm_pu_ok:
    ds_read_b128 v[104:107], v12 offset:57344
    ds_read_b64_tr_b16 v[80:81], v4 offset:0
    ds_read_b64_tr_b16 v[82:83], v4 offset:768
    v_mfma_f32_32x32x16_bf16 v[48:63], v[96:99], v[108:111], v[48:63]
    ds_read_b64_tr_b16 v[84:85], v5 offset:0
    ds_read_b64_tr_b16 v[86:87], v5 offset:768
    v_mfma_f32_32x32x16_bf16 v[64:79], v[100:103], v[108:111], v[64:79]
    ds_read_b64_tr_b16 v[88:89], v6 offset:0
    ds_read_b64_tr_b16 v[90:91], v6 offset:768
    v_mfma_f32_16x16x32_bf16 v[24:27], v[20:23], v[92:95], v[24:27]
    s_waitcnt lgkmcnt(4)
    v_mfma_f32_32x32x16_bf16 v[32:47], v[80:83], v[104:107], v[32:47]
    ds_read_b128 v[108:111], v13 offset:57344
    ds_read_b64_tr_b16 v[92:93], v4 offset:3072
    ds_read_b64_tr_b16 v[94:95], v4 offset:3840
    s_waitcnt lgkmcnt(5)
    v_mfma_f32_32x32x16_bf16 v[48:63], v[84:87], v[104:107], v[48:63]
    ds_read_b64_tr_b16 v[96:97], v5 offset:3072
    ds_read_b64_tr_b16 v[98:99], v5 offset:3840
    s_waitcnt lgkmcnt(5)
    v_mfma_f32_32x32x16_bf16 v[64:79], v[88:91], v[104:107], v[64:79]
    ds_read_b64_tr_b16 v[100:101], v6 offset:3072
    ds_read_b64_tr_b16 v[102:103], v6 offset:3840
    v_mfma_f32_16x16x32_bf16 v[24:27], v[20:23], v[80:83], v[24:27]
    s_lshl_b32 s3, s34, 2
    s_add_u32 s3, s3, s5
    s_mul_i32 s3, s3, 88
    s_lshl_b32 s3, s3, 10
    s_add_u32 s3, s3, 4194304
    s_mul_i32 s43, s35, 3
    v_lshlrev_b32 v2, 3, v19
    v_add_u32 v2, 152064, v2
    v_lshl_add_u32 v8, s44, 8, v2
    v_lshl_add_u32 v9, s45, 8, v2
    v_lshl_add_u32 v10, s46, 8, v2
    s_add_u32 s44, s44, s43
    s_cmp_lt_u32 s44, 43
    s_cselect_b32 s54, s3, 0x7ff00000
    s_lshl_b32 s44, s44, 11
    s_add_u32 s44, s44, s54
    s_add_u32 s45, s45, s43
    s_cmp_lt_u32 s45, 43
    s_cselect_b32 s54, s3, 0x7ff00000
    s_lshl_b32 s45, s45, 11
    s_add_u32 s45, s45, s54
    s_add_u32 s46, s46, s43
    s_cmp_lt_u32 s46, 43
    s_cselect_b32 s54, s3, 0x7ff00000
    s_lshl_b32 s46, s46, 11
    s_add_u32 s46, s46, s54
    s_waitcnt lgkmcnt(4)
    v_mfma_f32_32x32x16_bf16 v[32:47], v[92:95], v[108:111], v[32:47]
    ds_read_b128 v[104:107], v14 offset:57344
    ds_read_b64_tr_b16 v[80:81], v4 offset:6144
    ds_read_b64_tr_b16 v[82:83], v4 offset:6912
    s_waitcnt lgkmcnt(5)
    v_mfma_f32_32x32x16_bf16 v[48:63], v[96:99], v[108:111], v[48:63]
    ds_read_b64_tr_b16 v[84:85], v5 offset:6144
    ds_read_b64_tr_b16 v[86:87], v5 offset:6912
    s_waitcnt lgkmcnt(5)
    v_mfma_f32_32x32x16_bf16 v[64:79], v[100:103], v[108:111], v[64:79]
    ds_read_b64_tr_b16 v[88:89], v6 offset:6144
    ds_read_b64_tr_b16 v[90:91], v6 offset:6912
    v_mfma_f32_16x16x32_bf16 v[24:27], v[20:23], v[92:95], v[24:27]
    v_mov_b32 v116, 0
    v_mov_b32 v117, 0
    v_mov_b32 v118, 0
    v_mov_b32 v119, 0
    v_mov_b32 v120, 0
    v_mov_b32 v121, 0
    v_mov_b32 v122, 0
    v_mov_b32 v123, 0
    v_mov_b32 v124, 0
    v_mov_b32 v125, 0
    v_mov_b32 v126, 0
    v_mov_b32 v127, 0
    v_mov_b32 v128, 0
    v_mov_b32 v129, 0
    v_mov_b32 v130, 0
    v_mov_b32 v131, 0
    s_waitcnt lgkmcnt(4)
    v_mfma_f32_32x32x16_bf16 v[32:47], v[80:83], v[104:107], v[32:47]
    ds_read_b128 v[108:111], v15 offset:57344
    ds_read_b64_tr_b16 v[92:93], v4 offset:9216
    ds_read_b64_tr_b16 v[94:95], v4 offset:9984
    s_waitcnt lgkmcnt(5)
    v_mfma_f32_32x32x16_bf16 v[48:63], v[84:87], v[104:107], v[48:63]
    ds_read_b64_tr_b16 v[96:97], v5 offset:9216
    ds_read_b64_tr_b16 v[98:99], v5 offset:9984
    s_waitcnt lgkmcnt(5)
    v_mfma_f32_32x32x16_bf16 v[64:79], v[88:91], v[104:107], v[64:79]
    ds_read_b64_tr_b16 v[100:101], v6 offset:9216
    ds_read_b64_tr_b16 v[102:103], v6 offset:9984
    v_mfma_f32_16x16x32_bf16 v[24:27], v[20:23], v[80:83], v[24:27]
    s_waitcnt lgkmcnt(4)
    v_mfma_f32_32x32x16_bf16 v[32:47], v[92:95], v[108:111], v[32:47]
    s_waitcnt lgkmcnt(0)
    s_barrier
    ds_read_b128 v[104:107], v12 offset:0
    ds_read_b64_tr_b16 v[80:81], v16 offset:0
    ds_read_b64_tr_b16 v[82:83], v16 offset:768
    v_mfma_f32_32x32x16_bf16 v[48:63], v[96:99], v[108:111], v[48:63]
    ds_read_b64_tr_b16 v[84:85], v17 offset:0
    ds_read_b64_tr_b16 v[86:87], v17 offset:768
    v_mfma_f32_32x32x16_bf16 v[64:79], v[100:103], v[108:111], v[64:79]
    ds_read_b64_tr_b16 v[88:89], v18 offset:0
    ds_read_b64_tr_b16 v[90:91], v18 offset:768
    v_mfma_f32_16x16x32_bf16 v[24:27], v[20:23], v[92:95], v[24:27]
    s_waitcnt lgkmcnt(4)
    v_mfma_f32_32x32x16_bf16 v[32:47], v[80:83], v[104:107], v[32:47]
    ds_read_b128 v[108:111], v13 offset:0
    ds_read_b64_tr_b16 v[92:93], v16 offset:3072
    ds_read_b64_tr_b16 v[94:95], v16 offset:3840
    s_waitcnt lgkmcnt(5)
    v_mfma_f32_32x32x16_bf16 v[48:63], v[84:87], v[104:107], v[48:63]
    ds_read_b64_tr_b16 v[96:97], v17 offset:3072
    ds_read_b64_tr_b16 v[98:99], v17 offset:3840
    s_waitcnt lgkmcnt(5)
    v_mfma_f32_32x32x16_bf16 v[64:79], v[88:91], v[104:107], v[64:79]
    ds_read_b64_tr_b16 v[100:101], v18 offset:3072
    ds_read_b64_tr_b16 v[102:103], v18 offset:3840
    v_mfma_f32_16x16x32_bf16 v[24:27], v[20:23], v[80:83], v[24:27]
    s_waitcnt lgkmcnt(4)
    v_mfma_f32_32x32x16_bf16 v[32:47], v[92:95], v[108:111], v[32:47]
    ds_read_b128 v[104:107], v14 offset:0
    ds_read_b64_tr_b16 v[80:81], v16 offset:6144
    ds_read_b64_tr_b16 v[82:83], v16 offset:6912
    s_waitcnt lgkmcnt(5)
    v_mfma_f32_32x32x16_bf16 v[48:63], v[96:99], v[108:111], v[48:63]
    ds_read_b64_tr_b16 v[84:85], v17 offset:6144
    ds_read_b64_tr_b16 v[86:87], v17 offset:6912
    s_waitcnt lgkmcnt(5)
    v_mfma_f32_32x32x16_bf16 v[64:79], v[100:103], v[108:111], v[64:79]
    ds_read_b64_tr_b16 v[88:89], v18 offset:6144
    ds_read_b64_tr_b16 v[90:91], v18 offset:6912
    v_mfma_f32_16x16x32_bf16 v[24:27], v[20:23], v[92:95], v[24:27]
    s_waitcnt lgkmcnt(4)
    v_mfma_f32_32x32x16_bf16 v[32:47], v[80:83], v[104:107], v[32:47]
    ds_read_b128 v[108:111], v15 offset:0
    ds_read_b64_tr_b16 v[92:93], v16 offset:9216
    ds_read_b64_tr_b16 v[94:95], v16 offset:9984
    s_waitcnt lgkmcnt(5)
    v_mfma_f32_32x32x16_bf16 v[48:63], v[84:87], v[104:107], v[48:63]
    ds_read_b64_tr_b16 v[96:97], v17 offset:9216
    ds_read_b64_tr_b16 v[98:99], v17 offset:9984
    s_waitcnt lgkmcnt(5)
    v_mfma_f32_32x32x16_bf16 v[64:79], v[88:91], v[104:107], v[64:79]
    ds_read_b64_tr_b16 v[100:101], v18 offset:9216
    ds_read_b64_tr_b16 v[102:103], v18 offset:9984
    v_mfma_f32_16x16x32_bf16 v[24:27], v[20:23], v[80:83], v[24:27]
    s_waitcnt lgkmcnt(4)
    v_mfma_f32_32x32x16_bf16 v[32:47], v[92:95], v[108:111], v[32:47]
    s_waitcnt lgkmcnt(0)
    s_barrier
    ds_read_b128 v[104:107], v12 offset:28672
    ds_read_b64_tr_b16 v[80:81], v16 offset:28672
    ds_read_b64_tr_b16 v[82:83], v16 offset:29440
    v_mfma_f32_32x32x16_bf16 v[48:63], v[96:99], v[108:111], v[48:63]
    ds_read_b64_tr_b16 v[84:85], v17 offset:28672
    ds_read_b64_tr_b16 v[86:87], v17 offset:29440
    v_mfma_f32_32x32x16_bf16 v[64:79], v[100:103], v[108:111], v[64:79]
    ds_read_b64_tr_b16 v[88:89], v18 offset:28672
    ds_read_b64_tr_b16 v[90:91], v18 offset:29440
    v_mfma_f32_16x16x32_bf16 v[24:27], v[20:23], v[92:95], v[24:27]
    s_waitcnt lgkmcnt(4)
    v_mfma_f32_32x32x16_bf16 v[32:47], v[80:83], v[104:107], v[32:47]
    ds_read_b128 v[108:111], v13 offset:28672
    ds_read_b64_tr_b16 v[92:93], v16 offset:31744
    ds_read_b64_tr_b16 v[94:95], v16 offset:32512
    s_waitcnt lgkmcnt(5)
    v_mfma_f32_32x32x16_bf16 v[48:63], v[84:87], v[104:107], v[48:63]
    ds_read_b64_tr_b16 v[96:97], v17 offset:31744
    ds_read_b64_tr_b16 v[98:99], v17 offset:32512
    s_waitcnt lgkmcnt(5)
    v_mfma_f32_32x32x16_bf16 v[64:79], v[88:91], v[104:107], v[64:79]
    ds_read_b64_tr_b16 v[100:101], v18 offset:31744
    ds_read_b64_tr_b16 v[102:103], v18 offset:32512
    v_mfma_f32_16x16x32_bf16 v[24:27], v[20:23], v[80:83], v[24:27]
    s_waitcnt lgkmcnt(4)
    v_mfma_f32_32x32x16_bf16 v[32:47], v[92:95], v[108:111], v[32:47]
    ds_read_b128 v[104:107], v14 offset:28672
    ds_read_b64_tr_b16 v[80:81], v16 offset:34816
    ds_read_b64_tr_b16 v[82:83], v16 offset:35584
    s_waitcnt lgkmcnt(5)
    v_mfma_f32_32x32x16_bf16 v[48:63], v[96:99], v[108:111], v[48:63]
    ds_read_b64_tr_b16 v[84:85], v17 offset:34816
    ds_read_b64_tr_b16 v[86:87], v17 offset:35584
    s_waitcnt lgkmcnt(5)
    v_mfma_f32_32x32x16_bf16 v[64:79], v[100:103], v[108:111], v[64:79]
    ds_read_b64_tr_b16 v[88:89], v18 offset:34816
    ds_read_b64_tr_b16 v[90:91], v18 offset:35584
    v_mfma_f32_16x16x32_bf16 v[24:27], v[20:23], v[92:95], v[24:27]
    s_waitcnt lgkmcnt(4)
    v_mfma_f32_32x32x16_bf16 v[32:47], v[80:83], v[104:107], v[32:47]
    ds_read_b128 v[108:111], v15 offset:28672
    ds_read_b64_tr_b16 v[92:93], v16 offset:37888
    ds_read_b64_tr_b16 v[94:95], v16 offset:38656
    s_waitcnt lgkmcnt(5)
    v_mfma_f32_32x32x16_bf16 v[48:63], v[84:87], v[104:107], v[48:63]
    ds_read_b64_tr_b16 v[96:97], v17 offset:37888
    ds_read_b64_tr_b16 v[98:99], v17 offset:38656
    s_waitcnt lgkmcnt(5)
    v_mfma_f32_32x32x16_bf16 v[64:79], v[88:91], v[104:107], v[64:79]
    ds_read_b64_tr_b16 v[100:101], v18 offset:37888
    ds_read_b64_tr_b16 v[102:103], v18 offset:38656
    v_mfma_f32_16x16x32_bf16 v[24:27], v[20:23], v[80:83], v[24:27]
    s_waitcnt lgkmcnt(4)
    v_mfma_f32_32x32x16_bf16 v[32:47], v[92:95], v[108:111], v[32:47]
    s_waitcnt lgkmcnt(0)
    s_barrier
    ds_read_b128 v[104:107], v12 offset:57344
    ds_read_b64_tr_b16 v[80:81], v4 offset:0
    ds_read_b64_tr_b16 v[82:83], v4 offset:768
    v_mfma_f32_32x32x16_bf16 v[48:63], v[96:99], v[108:111], v[48:63]
    ds_read_b64_tr_b16 v[84:85], v5 offset:0
    ds_read_b64_tr_b16 v[86:87], v5 offset:768
    v_mfma_f32_32x32x16_bf16 v[64:79], v[100:103], v[108:111], v[64:79]
    ds_read_b64_tr_b16 v[88:89], v6 offset:0
    ds_read_b64_tr_b16 v[90:91], v6 offset:768
    v_mfma_f32_16x16x32_bf16 v[24:27], v[20:23], v[92:95], v[24:27]
    s_waitcnt lgkmcnt(4)
    v_mfma_f32_32x32x16_bf16 v[32:47], v[80:83], v[104:107], v[32:47]
    ds_read_b128 v[108:111], v13 offset:57344
    ds_read_b64_tr_b16 v[92:93], v4 offset:3072
    ds_read_b64_tr_b16 v[94:95], v4 offset:3840
    s_waitcnt lgkmcnt(5)
    v_mfma_f32_32x32x16_bf16 v[48:63], v[84:87], v[104:107], v[48:63]
    ds_read_b64_tr_b16 v[96:97], v5 offset:3072
    ds_read_b64_tr_b16 v[98:99], v5 offset:3840
    s_waitcnt lgkmcnt(5)
    v_mfma_f32_32x32x16_bf16 v[64:79], v[88:91], v[104:107], v[64:79]
    ds_read_b64_tr_b16 v[100:101], v6 offset:3072
    ds_read_b64_tr_b16 v[102:103], v6 offset:3840
    v_mfma_f32_16x16x32_bf16 v[24:27], v[20:23], v[80:83], v[24:27]
    s_waitcnt lgkmcnt(4)
    v_mfma_f32_32x32x16_bf16 v[32:47], v[92:95], v[108:111], v[32:47]
    ds_read_b128 v[104:107], v14 offset:57344
    ds_read_b64_tr_b16 v[80:81], v4 offset:6144
    ds_read_b64_tr_b16 v[82:83], v4 offset:6912
    s_waitcnt lgkmcnt(5)
    v_mfma_f32_32x32x16_bf16 v[48:63], v[96:99], v[108:111], v[48:63]
    ds_read_b64_tr_b16 v[84:85], v5 offset:6144
    ds_read_b64_tr_b16 v[86:87], v5 offset:6912
    s_waitcnt lgkmcnt(5)
    v_mfma_f32_32x32x16_bf16 v[64:79], v[100:103], v[108:111], v[64:79]
    ds_read_b64_tr_b16 v[88:89], v6 offset:6144
    ds_read_b64_tr_b16 v[90:91], v6 offset:6912
    v_mfma_f32_16x16x32_bf16 v[24:27], v[20:23], v[92:95], v[24:27]
    s_waitcnt lgkmcnt(4)
    v_mfma_f32_32x32x16_bf16 v[32:47], v[80:83], v[104:107], v[32:47]
    ds_read_b128 v[108:111], v15 offset:57344
    ds_read_b64_tr_b16 v[92:93], v4 offset:9216
    ds_read_b64_tr_b16 v[94:95], v4 offset:9984
    s_waitcnt lgkmcnt(5)
    v_mfma_f32_32x32x16_bf16 v[48:63], v[84:87], v[104:107], v[48:63]
    ds_read_b64_tr_b16 v[96:97], v5 offset:9216
    ds_read_b64_tr_b16 v[98:99], v5 offset:9984
    s_waitcnt lgkmcnt(5)
    v_mfma_f32_32x32x16_bf16 v[64:79], v[88:91], v[104:107], v[64:79]
    ds_read_b64_tr_b16 v[100:101], v6 offset:9216
    ds_read_b64_tr_b16 v[102:103], v6 offset:9984
    v_mfma_f32_16x16x32_bf16 v[24:27], v[20:23], v[80:83], v[24:27]
    s_waitcnt lgkmcnt(4)
    v_mfma_f32_32x32x16_bf16 v[32:47], v[92:95], v[108:111], v[32:47]
    s_waitcnt lgkmcnt(0)
    s_barrier
    ds_read_b128 v[104:107], v12 offset:0
    ds_read_b64_tr_b16 v[80:81], v16 offset:0
    ds_read_b64_tr_b16 v[82:83], v16 offset:768
    v_mfma_f32_32x32x16_bf16 v[48:63], v[96:99], v[108:111], v[48:63]
    ds_read_b64_tr_b16 v[84:85], v17 offset:0
    ds_read_b64_tr_b16 v[86:87], v17 offset:768
    v_mfma_f32_32x32x16_bf16 v[64:79], v[100:103], v[108:111], v[64:79]
    ds_read_b64_tr_b16 v[88:89], v18 offset:0
    ds_read_b64_tr_b16 v[90:91], v18 offset:768
    v_mfma_f32_16x16x32_bf16 v[24:27], v[20:23], v[92:95], v[24:27]
    s_waitcnt lgkmcnt(4)
    v_mfma_f32_32x32x16_bf16 v[32:47], v[80:83], v[104:107], v[32:47]
    ds_read_b128 v[108:111], v13 offset:0
    ds_read_b64_tr_b16 v[92:93], v16 offset:3072
    ds_read_b64_tr_b16 v[94:95], v16 offset:3840
    s_waitcnt lgkmcnt(5)
    v_mfma_f32_32x32x16_bf16 v[48:63], v[84:87], v[104:107], v[48:63]
    ds_read_b64_tr_b16 v[96:97], v17 offset:3072
    ds_read_b64_tr_b16 v[98:99], v17 offset:3840
    s_waitcnt lgkmcnt(5)
    v_mfma_f32_32x32x16_bf16 v[64:79], v[88:91], v[104:107], v[64:79]
    ds_read_b64_tr_b16 v[100:101], v18 offset:3072
    ds_read_b64_tr_b16 v[102:103], v18 offset:3840
    v_mfma_f32_16x16x32_bf16 v[24:27], v[20:23], v[80:83], v[24:27]
    s_waitcnt lgkmcnt(4)
    v_mfma_f32_32x32x16_bf16 v[32:47], v[92:95], v[108:111], v[32:47]
    ds_read_b128 v[104:107], v14 offset:0
    ds_read_b64_tr_b16 v[80:81], v16 offset:6144
    ds_read_b64_tr_b16 v[82:83], v16 offset:6912
    s_waitcnt lgkmcnt(5)
    v_mfma_f32_32x32x16_bf16 v[48:63], v[96:99], v[108:111], v[48:63]
    ds_read_b64_tr_b16 v[84:85], v17 offset:6144
    ds_read_b64_tr_b16 v[86:87], v17 offset:6912
    s_waitcnt lgkmcnt(5)
    v_mfma_f32_32x32x16_bf16 v[64:79], v[100:103], v[108:111], v[64:79]
    ds_read_b64_tr_b16 v[88:89], v18 offset:6144
    ds_read_b64_tr_b16 v[90:91], v18 offset:6912
    v_mfma_f32_16x16x32_bf16 v[24:27], v[20:23], v[92:95], v[24:27]
    buffer_load_dwordx2 v[112:113], v114, s[20:23], s47 offen sc1
    s_waitcnt lgkmcnt(4)
    v_mfma_f32_32x32x16_bf16 v[32:47], v[80:83], v[104:107], v[32:47]
    ds_read_b128 v[108:111], v15 offset:0
    ds_read_b64_tr_b16 v[92:93], v16 offset:9216
    ds_read_b64_tr_b16 v[94:95], v16 offset:9984
    s_waitcnt lgkmcnt(5)
    v_mfma_f32_32x32x16_bf16 v[48:63], v[84:87], v[104:107], v[48:63]
    ds_read_b64_tr_b16 v[96:97], v17 offset:9216
    ds_read_b64_tr_b16 v[98:99], v17 offset:9984
    s_waitcnt lgkmcnt(5)
    v_mfma_f32_32x32x16_bf16 v[64:79], v[88:91], v[104:107], v[64:79]
    ds_read_b64_tr_b16 v[100:101], v18 offset:9216
    ds_read_b64_tr_b16 v[102:103], v18 offset:9984
    v_mfma_f32_16x16x32_bf16 v[24:27], v[20:23], v[80:83], v[24:27]
    s_waitcnt lgkmcnt(4)
    v_mfma_f32_32x32x16_bf16 v[32:47], v[92:95], v[108:111], v[32:47]
    s_waitcnt lgkmcnt(0)
    s_barrier
    ds_read_b128 v[104:107], v12 offset:28672
    ds_read_b64_tr_b16 v[80:81], v16 offset:28672
    ds_read_b64_tr_b16 v[82:83], v16 offset:29440
    v_mfma_f32_32x32x16_bf16 v[48:63], v[96:99], v[108:111], v[48:63]
    ds_read_b64_tr_b16 v[84:85], v17 offset:28672
    ds_read_b64_tr_b16 v[86:87], v17 offset:29440
    v_mfma_f32_32x32x16_bf16 v[64:79], v[100:103], v[108:111], v[64:79]
    ds_read_b64_tr_b16 v[88:89], v18 offset:28672
    ds_read_b64_tr_b16 v[90:91], v18 offset:29440
    v_mfma_f32_16x16x32_bf16 v[24:27], v[20:23], v[92:95], v[24:27]
    s_waitcnt lgkmcnt(4)
    v_mfma_f32_32x32x16_bf16 v[32:47], v[80:83], v[104:107], v[32:47]
    ds_read_b128 v[108:111], v13 offset:28672
    ds_read_b64_tr_b16 v[92:93], v16 offset:31744
    ds_read_b64_tr_b16 v[94:95], v16 offset:32512
    s_waitcnt lgkmcnt(5)
    v_mfma_f32_32x32x16_bf16 v[48:63], v[84:87], v[104:107], v[48:63]
    ds_read_b64_tr_b16 v[96:97], v17 offset:31744
    ds_read_b64_tr_b16 v[98:99], v17 offset:32512
    s_waitcnt lgkmcnt(5)
    v_mfma_f32_32x32x16_bf16 v[64:79], v[88:91], v[104:107], v[64:79]
    ds_read_b64_tr_b16 v[100:101], v18 offset:31744
    ds_read_b64_tr_b16 v[102:103], v18 offset:32512
    v_mfma_f32_16x16x32_bf16 v[24:27], v[20:23], v[80:83], v[24:27]
    s_waitcnt lgkmcnt(4)
    v_mfma_f32_32x32x16_bf16 v[32:47], v[92:95], v[108:111], v[32:47]
    ds_read_b128 v[104:107], v14 offset:28672
    ds_read_b64_tr_b16 v[80:81], v16 offset:34816
    ds_read_b64_tr_b16 v[82:83], v16 offset:35584
    s_waitcnt lgkmcnt(5)
    v_mfma_f32_32x32x16_bf16 v[48:63], v[96:99], v[108:111], v[48:63]
    ds_read_b64_tr_b16 v[84:85], v17 offset:34816
    ds_read_b64_tr_b16 v[86:87], v17 offset:35584
    s_waitcnt lgkmcnt(5)
    v_mfma_f32_32x32x16_bf16 v[64:79], v[100:103], v[108:111], v[64:79]
    ds_read_b64_tr_b16 v[88:89], v18 offset:34816
    ds_read_b64_tr_b16 v[90:91], v18 offset:35584
    v_mfma_f32_16x16x32_bf16 v[24:27], v[20:23], v[92:95], v[24:27]
    s_waitcnt lgkmcnt(4)
    v_mfma_f32_32x32x16_bf16 v[32:47], v[80:83], v[104:107], v[32:47]
    ds_read_b128 v[108:111], v15 offset:28672
    ds_read_b64_tr_b16 v[92:93], v16 offset:37888
    ds_read_b64_tr_b16 v[94:95], v16 offset:38656
    s_waitcnt lgkmcnt(5)
    v_mfma_f32_32x32x16_bf16 v[48:63], v[84:87], v[104:107], v[48:63]
    ds_read_b64_tr_b16 v[96:97], v17 offset:37888
    ds_read_b64_tr_b16 v[98:99], v17 offset:38656
    s_waitcnt lgkmcnt(5)
    v_mfma_f32_32x32x16_bf16 v[64:79], v[88:91], v[104:107], v[64:79]
    ds_read_b64_tr_b16 v[100:101], v18 offset:37888
    ds_read_b64_tr_b16 v[102:103], v18 offset:38656
    v_mfma_f32_16x16x32_bf16 v[24:27], v[20:23], v[80:83], v[24:27]
    s_waitcnt lgkmcnt(4)
    v_mfma_f32_32x32x16_bf16 v[32:47], v[92:95], v[108:111], v[32:47]
    s_waitcnt lgkmcnt(0)
    s_barrier
    ds_read_b128 v[104:107], v12 offset:57344
    ds_read_b64_tr_b16 v[80:81], v4 offset:0
    ds_read_b64_tr_b16 v[82:83], v4 offset:768
    v_mfma_f32_32x32x16_bf16 v[48:63], v[96:99], v[108:111], v[48:63]
    ds_read_b64_tr_b16 v[84:85], v5 offset:0
    ds_read_b64_tr_b16 v[86:87], v5 offset:768
    v_mfma_f32_32x32x16_bf16 v[64:79], v[100:103], v[108:111], v[64:79]
    ds_read_b64_tr_b16 v[88:89], v6 offset:0
    ds_read_b64_tr_b16 v[90:91], v6 offset:768
    v_mfma_f32_16x16x32_bf16 v[24:27], v[20:23], v[92:95], v[24:27]
    s_waitcnt lgkmcnt(4)
    v_mfma_f32_32x32x16_bf16 v[32:47], v[80:83], v[104:107], v[32:47]
    ds_read_b128 v[108:111], v13 offset:57344
    ds_read_b64_tr_b16 v[92:93], v4 offset:3072
    ds_read_b64_tr_b16 v[94:95], v4 offset:3840
    s_waitcnt lgkmcnt(5)
    v_mfma_f32_32x32x16_bf16 v[48:63], v[84:87], v[104:107], v[48:63]
    ds_read_b64_tr_b16 v[96:97], v5 offset:3072
    ds_read_b64_tr_b16 v[98:99], v5 offset:3840
    s_waitcnt lgkmcnt(5)
    v_mfma_f32_32x32x16_bf16 v[64:79], v[88:91], v[104:107], v[64:79]
    ds_read_b64_tr_b16 v[100:101], v6 offset:3072
    ds_read_b64_tr_b16 v[102:103], v6 offset:3840
    v_mfma_f32_16x16x32_bf16 v[24:27], v[20:23], v[80:83], v[24:27]
    s_waitcnt lgkmcnt(4)
    v_mfma_f32_32x32x16_bf16 v[32:47], v[92:95], v[108:111], v[32:47]
    ds_read_b128 v[104:107], v14 offset:57344
    ds_read_b64_tr_b16 v[80:81], v4 offset:6144
    ds_read_b64_tr_b16 v[82:83], v4 offset:6912
    s_waitcnt lgkmcnt(5)
    v_mfma_f32_32x32x16_bf16 v[48:63], v[96:99], v[108:111], v[48:63]
    ds_read_b64_tr_b16 v[84:85], v5 offset:6144
    ds_read_b64_tr_b16 v[86:87], v5 offset:6912
    s_waitcnt lgkmcnt(5)
    v_mfma_f32_32x32x16_bf16 v[64:79], v[100:103], v[108:111], v[64:79]
    ds_read_b64_tr_b16 v[88:89], v6 offset:6144
    ds_read_b64_tr_b16 v[90:91], v6 offset:6912
    v_mfma_f32_16x16x32_bf16 v[24:27], v[20:23], v[92:95], v[24:27]
    s_waitcnt vmcnt(0)
Lg1_st:
    v_cmp_ne_u32 vcc, s6, v113
    s_cbranch_vccnz Lg1_st_r
Lg1_st_ok:
    v_xor_b32 v129, 0x8000, v112
    v_alignbit_b32 v128, v129, v129, 16
    v_and_b32 v129, 0xffff, v129
    s_waitcnt lgkmcnt(4)
    v_mfma_f32_32x32x16_bf16 v[32:47], v[80:83], v[104:107], v[32:47]
    ds_read_b128 v[108:111], v15 offset:57344
    ds_read_b64_tr_b16 v[92:93], v4 offset:9216
    ds_read_b64_tr_b16 v[94:95], v4 offset:9984
    s_waitcnt lgkmcnt(5)
    v_mfma_f32_32x32x16_bf16 v[48:63], v[84:87], v[104:107], v[48:63]
    ds_read_b64_tr_b16 v[96:97], v5 offset:9216
    ds_read_b64_tr_b16 v[98:99], v5 offset:9984
    s_waitcnt lgkmcnt(5)
    v_mfma_f32_32x32x16_bf16 v[64:79], v[88:91], v[104:107], v[64:79]
    ds_read_b64_tr_b16 v[100:101], v6 offset:9216
    ds_read_b64_tr_b16 v[102:103], v6 offset:9984
    v_mfma_f32_16x16x32_bf16 v[24:27], v[20:23], v[80:83], v[24:27]
    s_waitcnt lgkmcnt(4)
    v_mfma_f32_32x32x16_bf16 v[32:47], v[92:95], v[108:111], v[32:47]
    s_waitcnt lgkmcnt(2)
    v_mfma_f32_32x32x16_bf16 v[48:63], v[96:99], v[108:111], v[48:63]
    s_waitcnt lgkmcnt(0)
    v_mfma_f32_32x32x16_bf16 v[64:79], v[100:103], v[108:111], v[64:79]
    v_mfma_f32_16x16x32_bf16 v[24:27], v[20:23], v[92:95], v[24:27]
    s_nop 7
    v_cvt_pk_bf16_f32 v2, v24, v24
    v_and_b32 v2, 0xffff0000, v2
    v_sub_f32 v3, v24, v2
    s_mov_b32 exec_hi, 0
    v_cvt_pk_bf16_f32 v117, v3, v130
    v_or_b32 v116, v2, v28
    ds_write_b64 v8, v[116:117]
    ds_write_b32 v205, v112
    s_mov_b32 exec_hi, -1
    v_mfma_f32_32x32x16_bf16 v[32:47], v[116:119], v[128:131], v[32:47]
    v_add_u32 v6, 90112, v7
    v_mov_b32 v4, v208
    v_mov_b32 v5, v209
    s_waitcnt lgkmcnt(0)
    s_barrier
    s_mov_b32 exec_hi, 0
    ds_read_b64 v[120:121], v9
    ds_read_b64 v[124:125], v10
    s_mov_b32 exec_hi, -1
    ds_read_b32 v204, v207
    ds_read_b32 v206, v207 offset:128
    s_waitcnt lgkmcnt(3)
    v_mfma_f32_32x32x16_bf16 v[48:63], v[120:123], v[128:131], v[48:63]
    s_waitcnt lgkmcnt(2)
    v_mfma_f32_32x32x16_bf16 v[64:79], v[124:127], v[128:131], v[64:79]
    v_mul_f32_e64 v32, v32, |v32|
    v_mul_f32_e64 v33, v33, |v33|
    v_mul_f32_e64 v34, v34, |v34|
    v_mul_f32_e64 v35, v35, |v35|
    v_mul_f32_e64 v36, v36, |v36|
    v_mul_f32_e64 v37, v37, |v37|
    v_mul_f32_e64 v38, v38, |v38|
    v_mul_f32_e64 v39, v39, |v39|
    v_cvt_pk_bf16_f32 v32, v32, v33
    v_cvt_pk_bf16_f32 v33, v34, v35
    v_cvt_pk_bf16_f32 v34, v36, v37
    v_cvt_pk_bf16_f32 v35, v38, v39
    v_pk_max_i16 v32, v32, 0
    v_pk_max_i16 v33, v33, 0
    v_pk_max_i16 v34, v34, 0
    v_pk_max_i16 v35, v35, 0
    buffer_store_dwordx4 v[32:35], v7, s[20:23], s44 offen offset:0 sc1
    v_mul_f32_e64 v40, v40, |v40|
    v_mul_f32_e64 v41, v41, |v41|
    v_mul_f32_e64 v42, v42, |v42|
    v_mul_f32_e64 v43, v43, |v43|
    v_mul_f32_e64 v44, v44, |v44|
    v_mul_f32_e64 v45, v45, |v45|
    v_mul_f32_e64 v46, v46, |v46|
    v_mul_f32_e64 v47, v47, |v47|
    v_cvt_pk_bf16_f32 v36, v40, v41
    v_cvt_pk_bf16_f32 v37, v42, v43
    v_cvt_pk_bf16_f32 v38, v44, v45
    v_cvt_pk_bf16_f32 v39, v46, v47
    v_pk_max_i16 v36, v36, 0
    v_pk_max_i16 v37, v37, 0
    v_pk_max_i16 v38, v38, 0
    v_pk_max_i16 v39, v39, 0
    buffer_store_dwordx4 v[36:39], v7, s[20:23], s44 offen offset:1024 sc1
    v_mul_f32_e64 v48, v48, |v48|
    v_mul_f32_e64 v49, v49, |v49|
    v_mul_f32_e64 v50, v50, |v50|
    v_mul_f32_e64 v51, v51, |v51|
    v_mul_f32_e64 v52, v52, |v52|
    v_mul_f32_e64 v53, v53, |v53|
    v_mul_f32_e64 v54, v54, |v54|
    v_mul_f32_e64 v55, v55, |v55|
    v_cvt_pk_bf16_f32 v48, v48, v49
    v_cvt_pk_bf16_f32 v49, v50, v51
    v_cvt_pk_bf16_f32 v50, v52, v53
    v_cvt_pk_bf16_f32 v51, v54, v55
    v_pk_max_i16 v48, v48, 0
    v_pk_max_i16 v49, v49, 0
    v_pk_max_i16 v50, v50, 0
    v_pk_max_i16 v51, v51, 0
    buffer_store_dwordx4 v[48:51], v7, s[20:23], s45 offen offset:0 sc1
    v_mul_f32_e64 v56, v56, |v56|
    v_mul_f32_e64 v57, v57, |v57|
    v_mul_f32_e64 v58, v58, |v58|
    v_mul_f32_e64 v59, v59, |v59|
    v_mul_f32_e64 v60, v60, |v60|
    v_mul_f32_e64 v61, v61, |v61|
    v_mul_f32_e64 v62, v62, |v62|
    v_mul_f32_e64 v63, v63, |v63|
    v_cvt_pk_bf16_f32 v52, v56, v57
    v_cvt_pk_bf16_f32 v53, v58, v59
    v_cvt_pk_bf16_f32 v54, v60, v61
    v_cvt_pk_bf16_f32 v55, v62, v63
    v_pk_max_i16 v52, v52, 0
    v_pk_max_i16 v53, v53, 0
    v_pk_max_i16 v54, v54, 0
    v_pk_max_i16 v55, v55, 0
    buffer_store_dwordx4 v[52:55], v7, s[20:23], s45 offen offset:1024 sc1
    v_mul_f32_e64 v64, v64, |v64|
    v_mul_f32_e64 v65, v65, |v65|
    v_mul_f32_e64 v66, v66, |v66|
    v_mul_f32_e64 v67, v67, |v67|
    v_mul_f32_e64 v68, v68, |v68|
    v_mul_f32_e64 v69, v69, |v69|
    v_mul_f32_e64 v70, v70, |v70|
    v_mul_f32_e64 v71, v71, |v71|
    v_cvt_pk_bf16_f32 v64, v64, v65
    v_cvt_pk_bf16_f32 v65, v66, v67
    v_cvt_pk_bf16_f32 v66, v68, v69
    v_cvt_pk_bf16_f32 v67, v70, v71
    v_pk_max_i16 v64, v64, 0
    v_pk_max_i16 v65, v65, 0
    v_pk_max_i16 v66, v66, 0
    v_pk_max_i16 v67, v67, 0
    buffer_store_dwordx4 v[64:67], v7, s[20:23], s46 offen offset:0 sc1
    v_mul_f32_e64 v72, v72, |v72|
    v_mul_f32_e64 v73, v73, |v73|
    v_mul_f32_e64 v74, v74, |v74|
    v_mul_f32_e64 v75, v75, |v75|
    v_mul_f32_e64 v76, v76, |v76|
    v_mul_f32_e64 v77, v77, |v77|
    v_mul_f32_e64 v78, v78, |v78|
    v_mul_f32_e64 v79, v79, |v79|
    v_cvt_pk_bf16_f32 v68, v72, v73
    v_cvt_pk_bf16_f32 v69, v74, v75
    v_cvt_pk_bf16_f32 v70, v76, v77
    v_cvt_pk_bf16_f32 v71, v78, v79
    v_pk_max_i16 v68, v68, 0
    v_pk_max_i16 v69, v69, 0
    v_pk_max_i16 v70, v70, 0
    v_pk_max_i16 v71, v71, 0
    buffer_store_dwordx4 v[68:71], v7, s[20:23], s46 offen offset:1024 sc1
    s_add_u32 m0, s52, 65536
    s_add_u32 s53, s50, 65536
    buffer_load_dwordx4 v252, s[16:19], s53 offen offset:0 lds
    buffer_load_dwordx4 v253, s[16:19], s53 offen offset:1024 lds
    buffer_load_dwordx4 v254, s[16:19], s53 offen offset:2048 lds
    buffer_load_dwordx4 v255, s[16:19], s53 offen offset:3072 lds
    s_mul_i32 s51, s48, 180224
    s_mul_i32 s3, s5, 22528
    s_add_u32 s51, s51, s3
    s_add_u32 s51, s51, 4194304
    s_add_u32 s55, s51, 20480
    s_cmp_eq_u32 s5, 3
    s_cselect_b32 s55, 0x7ff00000, s55
    ds_read_b64_tr_b16 v[160:161], v244 offset:0
    ds_read_b64_tr_b16 v[162:163], v244 offset:1024
    ds_read_b64_tr_b16 v[164:165], v245 offset:0
    ds_read_b64_tr_b16 v[166:167], v245 offset:1024
    ds_read_b64_tr_b16 v[168:169], v244 offset:2048
    ds_read_b64_tr_b16 v[170:171], v244 offset:3072
    ds_read_b64_tr_b16 v[172:173], v245 offset:2048
    ds_read_b64_tr_b16 v[174:175], v245 offset:3072
    v_lshlrev_b32 v12, 3, v19
    v_lshl_add_u32 v28, v11, 15, v12
    v_and_b32 v13, 1, v1
    v_lshlrev_b32 v13, 4, v13
    v_lshrrev_b32_e64 v29, v13, s6
    v_lshrrev_b32 v31, 8, v29
    s_waitcnt lgkmcnt(8)
    v_permlane32_swap_b32 v192, v194
    v_permlane32_swap_b32 v193, v195
    v_permlane32_swap_b32 v196, v198
    v_permlane32_swap_b32 v197, v199
    v_and_b32 v8, 0xffff0000, v204
    v_mul_f32 v8, v8, v8
    v_rcp_f32 v2, v8
    v_and_b32 v9, 0xffff0000, v206
    v_mul_f32 v9, v9, v9
    v_rcp_f32 v3, v9
    s_waitcnt lgkmcnt(0)
    ds_read_b64_tr_b16 v[176:177], v244 offset:16384
    ds_read_b64_tr_b16 v[178:179], v244 offset:17408
    ds_read_b64_tr_b16 v[180:181], v245 offset:16384
    ds_read_b64_tr_b16 v[182:183], v245 offset:17408
    ds_read_b64_tr_b16 v[184:185], v244 offset:18432
    ds_read_b64_tr_b16 v[186:187], v244 offset:19456
    ds_read_b64_tr_b16 v[188:189], v245 offset:18432
    ds_read_b64_tr_b16 v[190:191], v245 offset:19456
    v_lshlrev_b32 v80, 16, v200
    v_and_b32 v81, 0xffff0000, v200
    v_lshlrev_b32 v82, 16, v201
    v_and_b32 v83, 0xffff0000, v201
    v_lshlrev_b32 v84, 16, v202
    v_and_b32 v85, 0xffff0000, v202
    v_lshlrev_b32 v86, 16, v203
    v_and_b32 v87, 0xffff0000, v203
    v_lshlrev_b32 v32, 16, v192
    v_and_b32 v33, 0xffff0000, v192
    v_lshlrev_b32 v34, 16, v193
    v_and_b32 v35, 0xffff0000, v193
    v_lshlrev_b32 v36, 16, v194
    v_and_b32 v37, 0xffff0000, v194
    v_lshlrev_b32 v38, 16, v195
    v_and_b32 v39, 0xffff0000, v195
    v_add_f32 v32, v32, v80
    v_add_f32 v33, v33, v81
    v_add_f32 v34, v34, v82
    v_add_f32 v35, v35, v83
    v_add_f32 v36, v36, v84
    v_add_f32 v37, v37, v85
    v_add_f32 v38, v38, v86
    v_add_f32 v39, v39, v87
    v_mul_f32 v32, v32, v8
    v_mul_f32 v33, v33, v8
    v_mul_f32 v34, v34, v8
    v_mul_f32 v35, v35, v8
    v_mul_f32 v36, v36, v8
    v_mul_f32 v37, v37, v8
    v_mul_f32 v38, v38, v8
    v_mul_f32 v39, v39, v8
    v_mov_b32 v40, 0
    v_mov_b32 v41, 0
    v_mov_b32 v42, 0
    v_mov_b32 v43, 0
    v_mov_b32 v44, 0
    v_mov_b32 v45, 0
    v_mov_b32 v46, 0
    v_mov_b32 v47, 0
    v_lshlrev_b32 v48, 16, v196
    v_and_b32 v49, 0xffff0000, v196
    v_lshlrev_b32 v50, 16, v197
    v_and_b32 v51, 0xffff0000, v197
    v_lshlrev_b32 v52, 16, v198
    v_and_b32 v53, 0xffff0000, v198
    v_lshlrev_b32 v54, 16, v199
    v_and_b32 v55, 0xffff0000, v199
    v_add_f32 v48, v48, v80
    v_add_f32 v49, v49, v81
    v_add_f32 v50, v50, v82
    v_add_f32 v51, v51, v83
    v_add_f32 v52, v52, v84
    v_add_f32 v53, v53, v85
    v_add_f32 v54, v54, v86
    v_add_f32 v55, v55, v87
    v_mul_f32 v48, v48, v9
    v_mul_f32 v49, v49, v9
    v_mul_f32 v50, v50, v9
    v_mul_f32 v51, v51, v9
    v_mul_f32 v52, v52, v9
    v_mul_f32 v53, v53, v9
    v_mul_f32 v54, v54, v9
    v_mul_f32 v55, v55, v9
    v_mov_b32 v56, 0
    v_mov_b32 v57, 0
    v_mov_b32 v58, 0
    v_mov_b32 v59, 0
    v_mov_b32 v60, 0
    v_mov_b32 v61, 0
    v_mov_b32 v62, 0
    v_mov_b32 v63, 0
    s_lshl_b32 s3, s49, 19
    s_lshl_b32 s44, s5, 17
    s_add_u32 s3, s3, s44
    s_lshl_b32 s44, s48, 9
    s_add_u32 s3, s3, s44
    s_add_u32 s47, s3, 10485760
    s_waitcnt vmcnt(4)
    s_mov_b64 exec, 1
    buffer_store_dword v247, v248, s[20:23], s38 offen sc1
    s_mov_b64 exec, -1
    s_waitcnt vmcnt(1)
    s_waitcnt lgkmcnt(0)
    ds_read_b64_tr_b16 v[192:193], v242 offset:0
    ds_read_b64_tr_b16 v[194:195], v242 offset:1024
    ds_read_b64_tr_b16 v[196:197], v243 offset:0
    ds_read_b64_tr_b16 v[198:199], v243 offset:1024
    ds_read_b64_tr_b16 v[200:201], v242 offset:2048
    ds_read_b64_tr_b16 v[202:203], v242 offset:3072
    ds_read_b64_tr_b16 v[204:205], v243 offset:2048
    ds_read_b64_tr_b16 v[206:207], v243 offset:3072
    s_waitcnt lgkmcnt(0)
    s_mov_b32 s42, 1600000
Lm_bu:
    ds_read_b32 v251, v250 offset:32
    s_waitcnt lgkmcnt(0)
    v_readfirstlane_b32 s3, v251
    s_sub_u32 s42, s42, 1
    s_cbranch_scc1 Lm_bu_ok
    s_cmp_ge_u32 s3, 4
    s_cbranch_scc1 Lm_bu_ok
    s_sleep 2
    s_branch Lm_bu
Lm_bu_ok:
    s_add_u32 m0, s52, 119296
    s_add_u32 s53, s50, 229376
    buffer_load_dwordx4 v252, s[16:19], s53 offen offset:0 lds
    buffer_load_dwordx4 v253, s[16:19], s53 offen offset:1024 lds
    buffer_load_dwordx4 v254, s[16:19], s53 offen offset:2048 lds
    buffer_load_dwordx4 v255, s[16:19], s53 offen offset:3072 lds
    s_add_u32 m0, s52, 135680
    s_add_u32 s53, s50, 262144
    buffer_load_dwordx4 v252, s[16:19], s53 offen offset:0 lds
    buffer_load_dwordx4 v253, s[16:19], s53 offen offset:1024 lds
    buffer_load_dwordx4 v254, s[16:19], s53 offen offset:2048 lds
    buffer_load_dwordx4 v255, s[16:19], s53 offen offset:3072 lds
    s_add_u32 m0, s52, 65536
    s_add_u32 s53, s50, 294912
    buffer_load_dwordx4 v252, s[16:19], s53 offen offset:0 lds
    buffer_load_dwordx4 v253, s[16:19], s53 offen offset:1024 lds
    buffer_load_dwordx4 v254, s[16:19], s53 offen offset:2048 lds
    buffer_load_dwordx4 v255, s[16:19], s53 offen offset:3072 lds
    s_mov_b32 s42, 1600000
Lm_kd:
    ds_read_b32 v251, v250 offset:8
    s_waitcnt lgkmcnt(0)
    v_readfirstlane_b32 s3, v251
    s_sub_u32 s42, s42, 1
    s_cbranch_scc1 Lm_kd_ok
    s_cmp_ge_u32 s3, 4
    s_cbranch_scc1 Lm_kd_ok
    s_sleep 2
    s_branch Lm_kd
Lm_kd_ok:
    s_add_u32 m0, s52, 0
    s_add_u32 s53, s50, 98304
    buffer_load_dwordx4 v252, s[16:19], s53 offen offset:0 lds
    buffer_load_dwordx4 v253, s[16:19], s53 offen offset:1024 lds
    buffer_load_dwordx4 v254, s[16:19], s53 offen offset:2048 lds
    buffer_load_dwordx4 v255, s[16:19], s53 offen offset:3072 lds
    s_add_u32 m0, s52, 16384
    s_add_u32 s53, s50, 131072
    buffer_load_dwordx4 v252, s[16:19], s53 offen offset:0 lds
    buffer_load_dwordx4 v253, s[16:19], s53 offen offset:1024 lds
    buffer_load_dwordx4 v254, s[16:19], s53 offen offset:2048 lds
    buffer_load_dwordx4 v255, s[16:19], s53 offen offset:3072 lds
    s_mov_b32 exec_lo, s37
    s_mov_b32 exec_hi, 0
    buffer_load_dword v30, v246, s[20:23], s36 offen sc1
    s_mov_b64 exec, -1
    s_add_u32 m0, s52, 32768
    s_add_u32 s53, s50, 163840
    buffer_load_dwordx4 v252, s[16:19], s53 offen offset:0 lds
    buffer_load_dwordx4 v253, s[16:19], s53 offen offset:1024 lds
    buffer_load_dwordx4 v254, s[16:19], s53 offen offset:2048 lds
    buffer_load_dwordx4 v255, s[16:19], s53 offen offset:3072 lds
    s_add_u32 m0, s52, 49152
    s_add_u32 s53, s50, 196608
    buffer_load_dwordx4 v252, s[16:19], s53 offen offset:0 lds
    buffer_load_dwordx4 v253, s[16:19], s53 offen offset:1024 lds
    buffer_load_dwordx4 v254, s[16:19], s53 offen offset:2048 lds
    buffer_load_dwordx4 v255, s[16:19], s53 offen offset:3072 lds
    s_waitcnt vmcnt(8)
Lg2_ph:
    v_cmp_ne_u32 vcc, s6, v30
    s_nop 0
    s_and_b32 s3, vcc_lo, s37
    s_cbranch_scc1 Lg2_ph_r
Lg2_ph_ok:
    s_add_u32 s43, s51, 0
    buffer_load_dwordx4 v[96:99], v7, s[20:23], s43 offen offset:0 sc1
    buffer_load_dwordx4 v[100:103], v6, s[20:23], s43 offen offset:0 sc1
    s_add_u32 s43, s51, 0
    buffer_load_dwordx4 v[104:107], v7, s[20:23], s43 offen offset:1024 sc1
    buffer_load_dwordx4 v[108:111], v6, s[20:23], s43 offen offset:1024 sc1
    s_add_u32 s43, s51, 2048
    buffer_load_dwordx4 v[112:115], v7, s[20:23], s43 offen offset:0 sc1
    buffer_load_dwordx4 v[116:119], v6, s[20:23], s43 offen offset:0 sc1
    s_add_u32 s43, s51, 2048
    buffer_load_dwordx4 v[120:123], v7, s[20:23], s43 offen offset:1024 sc1
    buffer_load_dwordx4 v[124:127], v6, s[20:23], s43 offen offset:1024 sc1
    s_add_u32 s43, s51, 4096
    buffer_load_dwordx4 v[128:131], v7, s[20:23], s43 offen offset:0 sc1
    buffer_load_dwordx4 v[132:135], v6, s[20:23], s43 offen offset:0 sc1
    s_add_u32 s43, s51, 4096
    buffer_load_dwordx4 v[136:139], v7, s[20:23], s43 offen offset:1024 sc1
    buffer_load_dwordx4 v[140:143], v6, s[20:23], s43 offen offset:1024 sc1
    s_add_u32 s43, s51, 6144
    buffer_load_dwordx4 v[144:147], v7, s[20:23], s43 offen offset:0 sc1
    buffer_load_dwordx4 v[148:151], v6, s[20:23], s43 offen offset:0 sc1
    s_add_u32 s43, s51, 6144
    buffer_load_dwordx4 v[152:155], v7, s[20:23], s43 offen offset:1024 sc1
    buffer_load_dwordx4 v[156:159], v6, s[20:23], s43 offen offset:1024 sc1
    s_waitcnt vmcnt(14)
    v_mfma_f32_32x32x16_bf16 v[32:47], v[160:163], v[96:99], v[32:47]
    v_mfma_f32_32x32x16_bf16 v[48:63], v[160:163], v[100:103], v[48:63]
    v_mfma_f32_32x32x16_bf16 v[64:79], v[164:167], v[96:99], 0
    v_mfma_f32_32x32x16_bf16 v[80:95], v[164:167], v[100:103], 0
    s_waitcnt vmcnt(12)
    v_mfma_f32_32x32x16_bf16 v[32:47], v[168:171], v[104:107], v[32:47]
    v_mfma_f32_32x32x16_bf16 v[48:63], v[168:171], v[108:111], v[48:63]
    s_add_u32 s43, s51, 8192
    buffer_load_dwordx4 v[96:99], v7, s[20:23], s43 offen offset:0 sc1
    v_mfma_f32_32x32x16_bf16 v[64:79], v[172:175], v[104:107], v[64:79]
    buffer_load_dwordx4 v[100:103], v6, s[20:23], s43 offen offset:0 sc1
    v_mfma_f32_32x32x16_bf16 v[80:95], v[172:175], v[108:111], v[80:95]
    s_waitcnt vmcnt(12)
    v_mfma_f32_32x32x16_bf16 v[32:47], v[176:179], v[112:115], v[32:47]
    v_mfma_f32_32x32x16_bf16 v[48:63], v[176:179], v[116:119], v[48:63]
    s_add_u32 s43, s51, 8192
    buffer_load_dwordx4 v[104:107], v7, s[20:23], s43 offen offset:1024 sc1
    v_mfma_f32_32x32x16_bf16 v[64:79], v[180:183], v[112:115], v[64:79]
    buffer_load_dwordx4 v[108:111], v6, s[20:23], s43 offen offset:1024 sc1
    v_mfma_f32_32x32x16_bf16 v[80:95], v[180:183], v[116:119], v[80:95]
    s_waitcnt vmcnt(12)
    v_mfma_f32_32x32x16_bf16 v[32:47], v[184:187], v[120:123], v[32:47]
    v_mfma_f32_32x32x16_bf16 v[48:63], v[184:187], v[124:127], v[48:63]
    s_add_u32 s43, s51, 10240
    buffer_load_dwordx4 v[112:115], v7, s[20:23], s43 offen offset:0 sc1
    v_mfma_f32_32x32x16_bf16 v[64:79], v[188:191], v[120:123], v[64:79]
    buffer_load_dwordx4 v[116:119], v6, s[20:23], s43 offen offset:0 sc1
    v_mfma_f32_32x32x16_bf16 v[80:95], v[188:191], v[124:127], v[80:95]
    s_waitcnt vmcnt(12)
    v_mfma_f32_32x32x16_bf16 v[32:47], v[192:195], v[128:131], v[32:47]
    v_mfma_f32_32x32x16_bf16 v[48:63], v[192:195], v[132:135], v[48:63]
    s_add_u32 s43, s51, 10240
    buffer_load_dwordx4 v[120:123], v7, s[20:23], s43 offen offset:1024 sc1
    v_mfma_f32_32x32x16_bf16 v[64:79], v[196:199], v[128:131], v[64:79]
    buffer_load_dwordx4 v[124:127], v6, s[20:23], s43 offen offset:1024 sc1
    v_mfma_f32_32x32x16_bf16 v[80:95], v[196:199], v[132:135], v[80:95]
    s_waitcnt vmcnt(12)
    v_mfma_f32_32x32x16_bf16 v[32:47], v[200:203], v[136:139], v[32:47]
    ds_read_b64_tr_b16 v[208:209], v240 offset:0
    ds_read_b64_tr_b16 v[210:211], v240 offset:1024
    ds_read_b64_tr_b16 v[212:213], v241 offset:0
    ds_read_b64_tr_b16 v[214:215], v241 offset:1024
    v_mfma_f32_32x32x16_bf16 v[48:63], v[200:203], v[140:143], v[48:63]
    s_add_u32 s43, s51, 12288
    buffer_load_dwordx4 v[128:131], v7, s[20:23], s43 offen offset:0 sc1
    v_mfma_f32_32x32x16_bf16 v[64:79], v[204:207], v[136:139], v[64:79]
    buffer_load_dwordx4 v[132:135], v6, s[20:23], s43 offen offset:0 sc1
    v_mfma_f32_32x32x16_bf16 v[80:95], v[204:207], v[140:143], v[80:95]
    s_waitcnt vmcnt(12)
    s_waitcnt lgkmcnt(0)
    v_mfma_f32_32x32x16_bf16 v[32:47], v[208:211], v[144:147], v[32:47]
    ds_read_b64_tr_b16 v[216:217], v240 offset:2048
    ds_read_b64_tr_b16 v[218:219], v240 offset:3072
    ds_read_b64_tr_b16 v[220:221], v241 offset:2048
    ds_read_b64_tr_b16 v[222:223], v241 offset:3072
    v_mfma_f32_32x32x16_bf16 v[48:63], v[208:211], v[148:151], v[48:63]
    s_add_u32 s43, s51, 12288
    buffer_load_dwordx4 v[136:139], v7, s[20:23], s43 offen offset:1024 sc1
    v_mfma_f32_32x32x16_bf16 v[64:79], v[212:215], v[144:147], v[64:79]
    buffer_load_dwordx4 v[140:143], v6, s[20:23], s43 offen offset:1024 sc1
    v_mfma_f32_32x32x16_bf16 v[80:95], v[212:215], v[148:151], v[80:95]
    s_waitcnt vmcnt(12)
    s_waitcnt lgkmcnt(0)
    v_mfma_f32_32x32x16_bf16 v[32:47], v[216:219], v[152:155], v[32:47]
    ds_read_b64_tr_b16 v[208:209], v240 offset:16384
    ds_read_b64_tr_b16 v[210:211], v240 offset:17408
    ds_read_b64_tr_b16 v[212:213], v241 offset:16384
    ds_read_b64_tr_b16 v[214:215], v241 offset:17408
    v_mfma_f32_32x32x16_bf16 v[48:63], v[216:219], v[156:159], v[48:63]
    s_add_u32 s43, s51, 14336
    buffer_load_dwordx4 v[144:147], v7, s[20:23], s43 offen offset:0 sc1
    v_mfma_f32_32x32x16_bf16 v[64:79], v[220:223], v[152:155], v[64:79]
    buffer_load_dwordx4 v[148:151], v6, s[20:23], s43 offen offset:0 sc1
    v_mfma_f32_32x32x16_bf16 v[80:95], v[220:223], v[156:159], v[80:95]
    s_waitcnt vmcnt(12)
    s_waitcnt lgkmcnt(0)
    v_mfma_f32_32x32x16_bf16 v[32:47], v[208:211], v[96:99], v[32:47]
    ds_read_b64_tr_b16 v[216:217], v240 offset:18432
    ds_read_b64_tr_b16 v[218:219], v240 offset:19456
    ds_read_b64_tr_b16 v[220:221], v241 offset:18432
    ds_read_b64_tr_b16 v[222:223], v241 offset:19456
    v_mfma_f32_32x32x16_bf16 v[48:63], v[208:211], v[100:103], v[48:63]
    s_add_u32 s43, s51, 14336
    buffer_load_dwordx4 v[152:155], v7, s[20:23], s43 offen offset:1024 sc1
    buffer_load_dwordx4 v[156:159], v6, s[20:23], s43 offen offset:1024 sc1
    v_mfma_f32_32x32x16_bf16 v[64:79], v[212:215], v[96:99], v[64:79]
    s_add_u32 m0, s52, 0
    s_add_u32 s53, s50, 327680
    buffer_load_dwordx4 v252, s[16:19], s53 offen offset:0 lds
    v_mfma_f32_32x32x16_bf16 v[80:95], v[212:215], v[100:103], v[80:95]
    buffer_load_dwordx4 v253, s[16:19], s53 offen offset:1024 lds
    s_waitcnt vmcnt(14)
    s_waitcnt lgkmcnt(0)
    v_mfma_f32_32x32x16_bf16 v[32:47], v[216:219], v[104:107], v[32:47]
    ds_read_b64_tr_b16 v[208:209], v240 offset:32768
    ds_read_b64_tr_b16 v[210:211], v240 offset:33792
    ds_read_b64_tr_b16 v[212:213], v241 offset:32768
    ds_read_b64_tr_b16 v[214:215], v241 offset:33792
    v_mfma_f32_32x32x16_bf16 v[48:63], v[216:219], v[108:111], v[48:63]
    s_add_u32 s43, s51, 16384
    buffer_load_dwordx4 v[96:99], v7, s[20:23], s43 offen offset:0 sc1
    buffer_load_dwordx4 v[100:103], v6, s[20:23], s43 offen offset:0 sc1
    v_mfma_f32_32x32x16_bf16 v[64:79], v[220:223], v[104:107], v[64:79]
    s_add_u32 m0, s52, 0
    s_add_u32 s53, s50, 327680
    buffer_load_dwordx4 v254, s[16:19], s53 offen offset:2048 lds
    v_mfma_f32_32x32x16_bf16 v[80:95], v[220:223], v[108:111], v[80:95]
    buffer_load_dwordx4 v255, s[16:19], s53 offen offset:3072 lds
    s_waitcnt vmcnt(16)
    s_waitcnt lgkmcnt(0)
    v_mfma_f32_32x32x16_bf16 v[32:47], v[208:211], v[112:115], v[32:47]
    ds_read_b64_tr_b16 v[216:217], v240 offset:34816
    ds_read_b64_tr_b16 v[218:219], v240 offset:35840
    ds_read_b64_tr_b16 v[220:221], v241 offset:34816
    ds_read_b64_tr_b16 v[222:223], v241 offset:35840
    v_mfma_f32_32x32x16_bf16 v[48:63], v[208:211], v[116:119], v[48:63]
    s_add_u32 s43, s51, 16384
    buffer_load_dwordx4 v[104:107], v7, s[20:23], s43 offen offset:1024 sc1
    v_mfma_f32_32x32x16_bf16 v[64:79], v[212:215], v[112:115], v[64:79]
    buffer_load_dwordx4 v[108:111], v6, s[20:23], s43 offen offset:1024 sc1
    v_mfma_f32_32x32x16_bf16 v[80:95], v[212:215], v[116:119], v[80:95]
    s_waitcnt vmcnt(16)
    s_waitcnt lgkmcnt(0)
    v_mfma_f32_32x32x16_bf16 v[32:47], v[216:219], v[120:123], v[32:47]
    ds_read_b64_tr_b16 v[208:209], v240 offset:49152
    ds_read_b64_tr_b16 v[210:211], v240 offset:50176
    ds_read_b64_tr_b16 v[212:213], v241 offset:49152
    ds_read_b64_tr_b16 v[214:215], v241 offset:50176
    v_mfma_f32_32x32x16_bf16 v[48:63], v[216:219], v[124:127], v[48:63]
    s_add_u32 s43, s51, 18432
    buffer_load_dwordx4 v[112:115], v7, s[20:23], s43 offen offset:0 sc1
    v_mfma_f32_32x32x16_bf16 v[64:79], v[220:223], v[120:123], v[64:79]
    buffer_load_dwordx4 v[116:119], v6, s[20:23], s43 offen offset:0 sc1
    v_mfma_f32_32x32x16_bf16 v[80:95], v[220:223], v[124:127], v[80:95]
    s_waitcnt vmcnt(16)
    s_waitcnt lgkmcnt(0)
    v_mfma_f32_32x32x16_bf16 v[32:47], v[208:211], v[128:131], v[32:47]
    ds_read_b64_tr_b16 v[216:217], v240 offset:51200
    ds_read_b64_tr_b16 v[218:219], v240 offset:52224
    ds_read_b64_tr_b16 v[220:221], v241 offset:51200
    ds_read_b64_tr_b16 v[222:223], v241 offset:52224
    v_mfma_f32_32x32x16_bf16 v[48:63], v[208:211], v[132:135], v[48:63]
    s_add_u32 s43, s51, 18432
    buffer_load_dwordx4 v[120:123], v7, s[20:23], s43 offen offset:1024 sc1
    v_mfma_f32_32x32x16_bf16 v[64:79], v[212:215], v[128:131], v[64:79]
    buffer_load_dwordx4 v[124:127], v6, s[20:23], s43 offen offset:1024 sc1
    v_mfma_f32_32x32x16_bf16 v[80:95], v[212:215], v[132:135], v[80:95]
    s_waitcnt vmcnt(16)
    s_waitcnt lgkmcnt(0)
    v_mfma_f32_32x32x16_bf16 v[32:47], v[216:219], v[136:139], v[32:47]
    ds_read_b64_tr_b16 v[208:209], v244 offset:0
    ds_read_b64_tr_b16 v[210:211], v244 offset:1024
    ds_read_b64_tr_b16 v[212:213], v245 offset:0
    ds_read_b64_tr_b16 v[214:215], v245 offset:1024
    v_mfma_f32_32x32x16_bf16 v[48:63], v[216:219], v[140:143], v[48:63]
    buffer_load_dwordx4 v[128:131], v7, s[20:23], s55 offen offset:0 sc1
    v_mfma_f32_32x32x16_bf16 v[64:79], v[220:223], v[136:139], v[64:79]
    buffer_load_dwordx4 v[132:135], v6, s[20:23], s55 offen offset:0 sc1
    v_mfma_f32_32x32x16_bf16 v[80:95], v[220:223], v[140:143], v[80:95]
    s_waitcnt vmcnt(16)
    s_waitcnt lgkmcnt(0)
    v_mfma_f32_32x32x16_bf16 v[32:47], v[208:211], v[144:147], v[32:47]
    ds_read_b64_tr_b16 v[216:217], v244 offset:2048
    ds_read_b64_tr_b16 v[218:219], v244 offset:3072
    ds_read_b64_tr_b16 v[220:221], v245 offset:2048
    ds_read_b64_tr_b16 v[222:223], v245 offset:3072
    v_mfma_f32_32x32x16_bf16 v[48:63], v[208:211], v[148:151], v[48:63]
    buffer_load_dwordx4 v[136:139], v7, s[20:23], s55 offen offset:1024 sc1
    v_mfma_f32_32x32x16_bf16 v[64:79], v[212:215], v[144:147], v[64:79]
    buffer_load_dwordx4 v[140:143], v6, s[20:23], s55 offen offset:1024 sc1
    v_mfma_f32_32x32x16_bf16 v[80:95], v[212:215], v[148:151], v[80:95]
    s_waitcnt vmcnt(16)
    s_waitcnt lgkmcnt(0)
    v_mfma_f32_32x32x16_bf16 v[32:47], v[216:219], v[152:155], v[32:47]
    ds_read_b64_tr_b16 v[208:209], v244 offset:16384
    ds_read_b64_tr_b16 v[210:211], v244 offset:17408
    ds_read_b64_tr_b16 v[212:213], v245 offset:16384
    ds_read_b64_tr_b16 v[214:215], v245 offset:17408
    v_mfma_f32_32x32x16_bf16 v[48:63], v[216:219], v[156:159], v[48:63]
    v_mfma_f32_32x32x16_bf16 v[64:79], v[220:223], v[152:155], v[64:79]
    v_mfma_f32_32x32x16_bf16 v[80:95], v[220:223], v[156:159], v[80:95]
    s_waitcnt vmcnt(12)
    s_waitcnt lgkmcnt(0)
    v_mfma_f32_32x32x16_bf16 v[32:47], v[208:211], v[96:99], v[32:47]
    ds_read_b64_tr_b16 v[216:217], v244 offset:18432
    ds_read_b64_tr_b16 v[218:219], v244 offset:19456
    ds_read_b64_tr_b16 v[220:221], v245 offset:18432
    ds_read_b64_tr_b16 v[222:223], v245 offset:19456
    v_mfma_f32_32x32x16_bf16 v[48:63], v[208:211], v[100:103], v[48:63]
    v_mfma_f32_32x32x16_bf16 v[64:79], v[212:215], v[96:99], v[64:79]
    v_mfma_f32_32x32x16_bf16 v[80:95], v[212:215], v[100:103], v[80:95]
    s_waitcnt vmcnt(8)
    s_waitcnt lgkmcnt(0)
    v_mfma_f32_32x32x16_bf16 v[32:47], v[216:219], v[104:107], v[32:47]
    ds_read_b64_tr_b16 v[208:209], v242 offset:0
    ds_read_b64_tr_b16 v[210:211], v242 offset:1024
    ds_read_b64_tr_b16 v[212:213], v243 offset:0
    ds_read_b64_tr_b16 v[214:215], v243 offset:1024
    v_mfma_f32_32x32x16_bf16 v[48:63], v[216:219], v[108:111], v[48:63]
    v_mfma_f32_32x32x16_bf16 v[64:79], v[220:223], v[104:107], v[64:79]
    v_mfma_f32_32x32x16_bf16 v[80:95], v[220:223], v[108:111], v[80:95]
    s_waitcnt vmcnt(6)
    s_waitcnt lgkmcnt(0)
    v_mfma_f32_32x32x16_bf16 v[32:47], v[208:211], v[112:115], v[32:47]
    ds_read_b64_tr_b16 v[216:217], v242 offset:2048
    ds_read_b64_tr_b16 v[218:219], v242 offset:3072
    ds_read_b64_tr_b16 v[220:221], v243 offset:2048
    ds_read_b64_tr_b16 v[222:223], v243 offset:3072
    v_mfma_f32_32x32x16_bf16 v[48:63], v[208:211], v[116:119], v[48:63]
    s_add_u32 s44, s47, 0
    buffer_load_dwordx2 v[224:225], v28, s[20:23], s44 offen offset:0 sc1
    buffer_load_dwordx2 v[232:233], v28, s[20:23], s44 offen offset:256 sc1
    v_mfma_f32_32x32x16_bf16 v[64:79], v[212:215], v[112:115], v[64:79]
    s_add_u32 s44, s47, 16384
    buffer_load_dwordx2 v[226:227], v28, s[20:23], s44 offen offset:0 sc1
    v_mfma_f32_32x32x16_bf16 v[80:95], v[212:215], v[116:119], v[80:95]
    buffer_load_dwordx2 v[234:235], v28, s[20:23], s44 offen offset:256 sc1
    s_waitcnt vmcnt(8)
    s_waitcnt lgkmcnt(0)
    v_mfma_f32_32x32x16_bf16 v[32:47], v[216:219], v[120:123], v[32:47]
    ds_read_b64_tr_b16 v[208:209], v240 offset:0
    ds_read_b64_tr_b16 v[210:211], v240 offset:1024
    ds_read_b64_tr_b16 v[212:213], v241 offset:0
    ds_read_b64_tr_b16 v[214:215], v241 offset:1024
    v_mfma_f32_32x32x16_bf16 v[48:63], v[216:219], v[124:127], v[48:63]
    s_add_u32 s44, s47, 65536
    buffer_load_dwordx2 v[228:229], v28, s[20:23], s44 offen offset:0 sc1
    buffer_load_dwordx2 v[236:237], v28, s[20:23], s44 offen offset:256 sc1
    v_mfma_f32_32x32x16_bf16 v[64:79], v[220:223], v[120:123], v[64:79]
    s_add_u32 s44, s47, 81920
    buffer_load_dwordx2 v[230:231], v28, s[20:23], s44 offen offset:0 sc1
    v_mfma_f32_32x32x16_bf16 v[80:95], v[220:223], v[124:127], v[80:95]
    buffer_load_dwordx2 v[238:239], v28, s[20:23], s44 offen offset:256 sc1
    s_waitcnt vmcnt(10)
    s_waitcnt lgkmcnt(0)
    v_mfma_f32_32x32x16_bf16 v[32:47], v[208:211], v[128:131], v[32:47]
    ds_read_b64_tr_b16 v[216:217], v240 offset:2048
    ds_read_b64_tr_b16 v[218:219], v240 offset:3072
    ds_read_b64_tr_b16 v[220:221], v241 offset:2048
    ds_read_b64_tr_b16 v[222:223], v241 offset:3072
    v_mfma_f32_32x32x16_bf16 v[48:63], v[208:211], v[132:135], v[48:63]
    v_mfma_f32_32x32x16_bf16 v[64:79], v[212:215], v[128:131], v[64:79]
    v_mfma_f32_32x32x16_bf16 v[80:95], v[212:215], v[132:135], v[80:95]
    s_waitcnt vmcnt(8)
    s_waitcnt lgkmcnt(0)
    v_mfma_f32_32x32x16_bf16 v[64:79], v[220:223], v[136:139], v[64:79]
    v_mfma_f32_32x32x16_bf16 v[80:95], v[220:223], v[140:143], v[80:95]
    v_mfma_f32_32x32x16_bf16 v[32:47], v[216:219], v[136:139], v[32:47]
    v_mfma_f32_32x32x16_bf16 v[48:63], v[216:219], v[140:143], v[48:63]
    v_add_u32 v12, s52, v7
    s_xor_b32 s3, s5, 1
    s_lshl_b32 s3, s3, 12
    v_add_u32 v21, s3, v7
    s_xor_b32 s3, s5, 2
    s_lshl_b32 s3, s3, 12
    v_add_u32 v22, s3, v7
    s_xor_b32 s3, s5, 3
    s_lshl_b32 s3, s3, 12
    v_add_u32 v23, s3, v7
    ds_write_b128 v12, v[64:67] offset:32768
    ds_write_b128 v12, v[68:71] offset:33792
    ds_write_b128 v12, v[80:83] offset:34816
    ds_write_b128 v12, v[84:87] offset:35840
    ds_write_b128 v12, v[72:75] offset:49152
    ds_write_b128 v12, v[76:79] offset:50176
    ds_write_b128 v12, v[88:91] offset:51200
    ds_write_b128 v12, v[92:95] offset:52224
    ds_write_b128 v12, v[40:43] offset:16384
    ds_write_b128 v12, v[44:47] offset:17408
    ds_write_b128 v12, v[56:59] offset:18432
    ds_write_b128 v12, v[60:63] offset:19456
    s_waitcnt vmcnt(0)
Lyc:
    v_xor_b32 v14, v224, v29
    v_xor_b32 v15, v225, v31
    v_or_b32 v13, v14, v15
    v_xor_b32 v14, v226, v29
    v_xor_b32 v15, v227, v31
    v_or3_b32 v13, v13, v14, v15
    v_xor_b32 v14, v228, v29
    v_xor_b32 v15, v229, v31
    v_or3_b32 v13, v13, v14, v15
    v_xor_b32 v14, v230, v29
    v_xor_b32 v15, v231, v31
    v_or3_b32 v13, v13, v14, v15
    v_xor_b32 v14, v232, v29
    v_xor_b32 v15, v233, v31
    v_or3_b32 v13, v13, v14, v15
    v_xor_b32 v14, v234, v29
    v_xor_b32 v15, v235, v31
    v_or3_b32 v13, v13, v14, v15
    v_xor_b32 v14, v236, v29
    v_xor_b32 v15, v237, v31
    v_or3_b32 v13, v13, v14, v15
    v_xor_b32 v14, v238, v29
    v_xor_b32 v15, v239, v31
    v_or3_b32 v13, v13, v14, v15
    v_and_b32 v13, 0xff, v13
    v_cmp_ne_u32 vcc, 0, v13
    s_cbranch_vccnz Lyr
Lyk:
    s_waitcnt lgkmcnt(0)
    s_barrier
    ds_read_b128 v[96:99], v21 offset:16384
    ds_read_b128 v[100:103], v21 offset:17408
    ds_read_b128 v[104:107], v21 offset:18432
    ds_read_b128 v[108:111], v21 offset:19456
    ds_read_b128 v[112:115], v22 offset:32768
    ds_read_b128 v[116:119], v22 offset:33792
    ds_read_b128 v[120:123], v22 offset:34816
    ds_read_b128 v[124:127], v22 offset:35840
    ds_read_b128 v[128:131], v23 offset:49152
    ds_read_b128 v[132:135], v23 offset:50176
    ds_read_b128 v[136:139], v23 offset:51200
    ds_read_b128 v[140:143], v23 offset:52224
    s_waitcnt lgkmcnt(8)
    v_pk_add_f32 v[32:33], v[32:33], v[96:97]
    v_pk_add_f32 v[34:35], v[34:35], v[98:99]
    v_pk_add_f32 v[36:37], v[36:37], v[100:101]
    v_pk_add_f32 v[38:39], v[38:39], v[102:103]
    v_pk_add_f32 v[48:49], v[48:49], v[104:105]
    v_pk_add_f32 v[50:51], v[50:51], v[106:107]
    v_pk_add_f32 v[52:53], v[52:53], v[108:109]
    v_pk_add_f32 v[54:55], v[54:55], v[110:111]
    s_waitcnt lgkmcnt(4)
    v_pk_add_f32 v[32:33], v[32:33], v[112:113]
    v_pk_add_f32 v[34:35], v[34:35], v[114:115]
    v_pk_add_f32 v[36:37], v[36:37], v[116:117]
    v_pk_add_f32 v[38:39], v[38:39], v[118:119]
    v_pk_add_f32 v[48:49], v[48:49], v[120:121]
    v_pk_add_f32 v[50:51], v[50:51], v[122:123]
    v_pk_add_f32 v[52:53], v[52:53], v[124:125]
    v_pk_add_f32 v[54:55], v[54:55], v[126:127]
    s_waitcnt lgkmcnt(0)
    v_pk_add_f32 v[32:33], v[32:33], v[128:129]
    v_pk_add_f32 v[34:35], v[34:35], v[130:131]
    v_pk_add_f32 v[36:37], v[36:37], v[132:133]
    v_pk_add_f32 v[38:39], v[38:39], v[134:135]
    v_pk_add_f32 v[48:49], v[48:49], v[136:137]
    v_pk_add_f32 v[50:51], v[50:51], v[138:139]
    v_pk_add_f32 v[52:53], v[52:53], v[140:141]
    v_pk_add_f32 v[54:55], v[54:55], v[142:143]
    v_pk_fma_f32 v[32:33], v[32:33], v[2:3], v[224:225] op_sel:[0,0,0] op_sel_hi:[1,0,1]
    v_pk_fma_f32 v[34:35], v[34:35], v[2:3], v[226:227] op_sel:[0,0,0] op_sel_hi:[1,0,1]
    v_pk_fma_f32 v[36:37], v[36:37], v[2:3], v[228:229] op_sel:[0,0,0] op_sel_hi:[1,0,1]
    v_pk_fma_f32 v[38:39], v[38:39], v[2:3], v[230:231] op_sel:[0,0,0] op_sel_hi:[1,0,1]
    v_cvt_pk_bf16_f32 v16, v32, v33
    v_cvt_pk_bf16_f32 v17, v34, v35
    v_cvt_pk_bf16_f32 v18, v36, v37
    v_cvt_pk_bf16_f32 v19, v38, v39
    s_nop 0
    v_permlane32_swap_b32 v16, v18
    v_permlane32_swap_b32 v17, v19
    buffer_store_dwordx4 v[16:19], v4, s[24:27], 0 offen nt
    v_pk_fma_f32 v[48:49], v[48:49], v[2:3], v[232:233] op_sel:[0,1,0] op_sel_hi:[1,1,1]
    v_pk_fma_f32 v[50:51], v[50:51], v[2:3], v[234:235] op_sel:[0,1,0] op_sel_hi:[1,1,1]
    v_pk_fma_f32 v[52:53], v[52:53], v[2:3], v[236:237] op_sel:[0,1,0] op_sel_hi:[1,1,1]
    v_pk_fma_f32 v[54:55], v[54:55], v[2:3], v[238:239] op_sel:[0,1,0] op_sel_hi:[1,1,1]
    v_cvt_pk_bf16_f32 v20, v48, v49
    v_cvt_pk_bf16_f32 v21, v50, v51
    v_cvt_pk_bf16_f32 v22, v52, v53
    v_cvt_pk_bf16_f32 v23, v54, v55
    s_nop 0
    v_permlane32_swap_b32 v20, v22
    v_permlane32_swap_b32 v21, v23
    buffer_store_dwordx4 v[20:23], v5, s[24:27], 0 offen nt
    s_endpgm
Lm_pu:
    v_mov_b32 v2, s6
    v_mov_b32 v3, 0
    s_mov_b64 exec, 1
    buffer_store_dword v2, v3, s[20:23], s55 offen sc1
    s_mov_b64 exec, -1
    s_branch Lm_pu_ok
Lg1_st_r:
    s_sub_u32 s41, s41, 8
    s_cselect_b32 s41, 0, s41
    s_cbranch_scc1 Lg1_st_ok
    s_sleep 4
    buffer_load_dwordx2 v[112:113], v114, s[20:23], s47 offen sc1
    s_waitcnt vmcnt(0)
    s_branch Lg1_st
Lg2_ph_r:
    s_sub_u32 s41, s41, 8
    s_cselect_b32 s41, 0, s41
    s_cbranch_scc1 Lg2_ph_ok
    s_sleep 1
    s_mov_b32 exec_lo, s3
    s_mov_b32 exec_hi, 0
    buffer_load_dword v30, v246, s[20:23], s36 offen sc1
    s_mov_b64 exec, -1
    s_waitcnt vmcnt(0)
    s_branch Lg2_ph
Lyr:
    s_sub_u32 s41, s41, 8
    s_cselect_b32 s41, 0, s41
    s_cbranch_scc1 Lyk
    s_sleep 2
    s_add_u32 s44, s47, 0
    buffer_load_dwordx2 v[224:225], v28, s[20:23], s44 offen offset:0 sc1
    buffer_load_dwordx2 v[232:233], v28, s[20:23], s44 offen offset:256 sc1
    s_add_u32 s44, s47, 16384
    buffer_load_dwordx2 v[226:227], v28, s[20:23], s44 offen offset:0 sc1
    buffer_load_dwordx2 v[234:235], v28, s[20:23], s44 offen offset:256 sc1
    s_add_u32 s44, s47, 65536
    buffer_load_dwordx2 v[228:229], v28, s[20:23], s44 offen offset:0 sc1
    buffer_load_dwordx2 v[236:237], v28, s[20:23], s44 offen offset:256 sc1
    s_add_u32 s44, s47, 81920
    buffer_load_dwordx2 v[230:231], v28, s[20:23], s44 offen offset:0 sc1
    buffer_load_dwordx2 v[238:239], v28, s[20:23], s44 offen offset:256 sc1
    s_waitcnt vmcnt(0)
    s_branch Lyc
Lexit:
    s_endpgm
.section .rodata,"a"
.p2align 6
.amdhsa_kernel parallel_sum__ssm_conv_s4d__dense_activation_squared_relu__prompt_kernel
  .amdhsa_next_free_vgpr 256
  .amdhsa_next_free_sgpr 64
  .amdhsa_accum_offset 256
  .amdhsa_group_segment_fixed_size 0
  .amdhsa_kernarg_size 120
  .amdhsa_user_sgpr_count 2
  .amdhsa_user_sgpr_kernarg_segment_ptr 1
  .amdhsa_system_sgpr_workgroup_id_x 1
.end_amdhsa_kernel
```
